```python
import torch

def _softmax(x, axis=-1):
    return torch.softmax(x, dim=axis)
def _gelu(x):
    return torch.nn.functional.gelu(x, approximate="tanh")
def _silu(x):
    return torch.nn.functional.silu(x)
def _sigmoid(x):
    return torch.sigmoid(x)
def _layernorm(x, axis=-1, eps=1e-5):
    m = x.mean(dim=axis, keepdim=True)
    v = x.var(dim=axis, keepdim=True, unbiased=False)
    return (x - m) / torch.sqrt(v + eps)
def _scatter_add(tgt, idx, src, axis=0):
    return tgt.clone().index_add_(axis, idx, src)
def _segment_sum(src, seg, n):
    out = torch.zeros((n,) + src.shape[1:], dtype=src.dtype)
    return out.index_add_(0, seg, src)
def _pad(x, pw):
    flat = tuple(v for pair in reversed(pw) for v in pair)
    return torch.nn.functional.pad(x, flat)

kernel_name = 'gated_mix__ssm_conv_s4d__grouped_kv_mqa__prompt'

def setup_inputs():

    _w = (lambda a: (lambda t: t.to(torch.bfloat16) if t.is_floating_point() else t)(torch.as_tensor(a)))
    def _A_setup():
        Bsz, L, D, N = 1, 2048, 640, 128
        return {
            "u": _w((lambda *s: torch.randn(*s, dtype=torch.bfloat16) * 0.05)(Bsz, L, D)),
            "log_A_real": _w((lambda *s: torch.randn(*s, dtype=torch.bfloat16) * 6.4)(D, N) * 0.5),
            "A_imag": _w((lambda *s: torch.randn(*s, dtype=torch.bfloat16) * 0.05)(D, N) * 3.14),
            "C_real": _w((lambda *s: torch.randn(*s, dtype=torch.bfloat16) * 0.05)(D, N) / N ** 0.5),
            "C_imag": _w((lambda *s: torch.randn(*s, dtype=torch.bfloat16) * 0.05)(D, N) / N ** 0.5),
            "log_dt": _w((lambda *s: torch.randn(*s, dtype=torch.bfloat16) * 0.05)(D) * 0.5 - 4.0),
            "D_skip": _w((lambda *s: torch.randn(*s, dtype=torch.bfloat16) * 0.05)(D)),
        }
    _A_in = _A_setup()

    def _B_setup():
        B, S, D, H = 1, 2048, 640, 32
        Dh = D // H
        return {
            "x": _w((lambda *s: torch.randn(*s, dtype=torch.bfloat16) * 0.05)(B, S, D)),
            "wq": _w((lambda *s: torch.randn(*s, dtype=torch.bfloat16) * 0.8)(D, H * Dh)),
            "wk": _w((lambda *s: torch.randn(*s, dtype=torch.bfloat16) * 0.8)(D, Dh)),
            "wv": _w((lambda *s: torch.randn(*s, dtype=torch.bfloat16) * 0.05)(D, Dh)),
            "wo": _w((lambda *s: torch.randn(*s, dtype=torch.bfloat16) * 0.05)(H * Dh, D)),
        }
    _B_in = _B_setup()

    return {
        "A_u": _A_in["u"],
        "A_log_A_real": _A_in["log_A_real"],
        "A_A_imag": _A_in["A_imag"],
        "A_C_real": _A_in["C_real"],
        "A_C_imag": _A_in["C_imag"],
        "A_log_dt": _A_in["log_dt"],
        "A_D_skip": _A_in["D_skip"],
        "B_x": _B_in["x"],
        "B_wq": _B_in["wq"],
        "B_wk": _B_in["wk"],
        "B_wv": _B_in["wv"],
        "B_wo": _B_in["wo"],
        "gate_w": _w((lambda *s: torch.randn(*s, dtype=torch.bfloat16) * 0.05)(640) * 16.0),
    }

def reference(A_u, A_log_A_real, A_A_imag, A_C_real, A_C_imag, A_log_dt, A_D_skip, B_x, B_wq, B_wk, B_wv, B_wo, gate_w):
    def _A_ref(u, log_A_real, A_imag, C_real, C_imag, log_dt, D_skip):
        L = u.shape[1]
        dt = torch.exp(log_dt)
        A = -torch.exp(log_A_real) + 1j * A_imag
        C = (C_real + 1j * C_imag) * dt[:, None]
        pos = (lambda x, dt: x.to(dt))(torch.arange(L), log_dt.dtype)
        P = torch.exp((A * dt[:, None])[:, :, None] * pos[None, None, :])
        K = 2.0 * torch.einsum("dn,dnl->dl", C, P).real
        L2 = 2 * L
        u_t = (lambda x, *d: x.permute(*d))(u, 0, 2, 1)
        Kf = (lambda x, *a, **k: torch.fft.rfft(x.float(), *a, **k))(K, L2)
        Uf = (lambda x, *a, **k: torch.fft.rfft(x.float(), *a, **k))(u_t, L2)
        y = (lambda x, *a, **k: torch.fft.irfft(x, *a, **k).to(torch.bfloat16))(Uf * Kf[None, :, :], L2)[:, :, :L]
        y = (lambda x, *d: x.permute(*d))(y, 0, 2, 1)
        return y + u * D_skip[None, None, :]

    def _B_ref(x, wq, wk, wv, wo):
        B, S, D = x.shape
        H = 32
        Dh = D // H
        q = (lambda x, *d: x.permute(*d))((x @ wq).reshape(B, S, H, Dh), 0, 2, 1, 3)
        k = x @ wk
        v = x @ wv
        scores = torch.einsum("bhqd,bkd->bhqk", q, k) * (Dh ** -0.5)
        p = _softmax(scores, axis=-1)
        o = torch.einsum("bhqk,bkd->bhqd", p, v)
        return (lambda x, *d: x.permute(*d))(o, 0, 2, 1, 3).reshape(B, S, H * Dh) @ wo

    x = A_u
    g = _sigmoid((x * gate_w).sum(-1, keepdims=True))
    a = _A_ref(x, A_log_A_real, A_A_imag, A_C_real, A_C_imag, A_log_dt, A_D_skip)
    b = _B_ref(x, B_wq, B_wk, B_wv, B_wo)
    return g * a + (1 - g) * b
```

```asm
; @launch grid=(256,1,1) block=(512,1,1) lds=163840
.amdgcn_target "amdgcn-amd-amdhsa--gfx950"
.text
.globl gated_mix__ssm_conv_s4d__grouped_kv_mqa__prompt_kernel
.p2align 8
.type gated_mix__ssm_conv_s4d__grouped_kv_mqa__prompt_kernel,@function
gated_mix__ssm_conv_s4d__grouped_kv_mqa__prompt_kernel:
    s_cmp_ge_u32 s2, 256
    s_cbranch_scc1 L_end
    s_load_dwordx16 s[36:51], s[0:1], 0
    s_load_dwordx16 s[52:67], s[0:1], 64
    s_getpc_b64 s[16:17]
    s_and_b32 s17, s17, 0xffff
    s_mov_b32 s18, L_end-L_nocpf
    s_mov_b32 s19, 0x00020000
    v_lshrrev_b32 v6, 6, v0
    s_bfe_u32 s3, s2, 0x20003
    v_and_b32 v6, 3, v6
    v_cmp_eq_u32 vcc, s3, v6
    v_lshlrev_b32 v6, 7, v0
    s_nop 3
    s_cbranch_vccz L_nocpf
    buffer_load_dword v9, v6, s[16:19], 0 offen
L_nocpf:
    v_lshrrev_b32 v5, 6, v0
    v_and_b32 v1, 63, v0
    v_readfirstlane_b32 s68, v5
    v_and_b32 v2, 31, v0
    v_bfe_u32 v3, v0, 5, 1
    v_lshlrev_b32 v4, 4, v1
    s_and_b32 s69, s2, 7
    s_lshl_b32 s69, s69, 2
    s_bfe_u32 s72, s2, 0x20003
    s_add_u32 s69, s69, s72
    s_lshr_b32 s70, s2, 5
    s_mov_b32 s92, 0xffff0000
    s_mov_b32 s88, 0
    s_mov_b32 s89, -1
    s_mov_b32 s87, 0
    s_lshr_b32 s6, s2, 1
    s_mul_i32 s6, s6, 5
    s_and_b32 s72, s2, 1
    s_lshl_b32 s72, s72, 1
    s_add_u32 s6, s6, s72
    s_and_b32 s86, s69, 3
    s_lshl_b32 s86, s86, 1
    s_add_u32 s86, s86, s70
    s_add_u32 s86, s86, 2
    s_cmp_ge_u32 s86, 10
    s_cselect_b32 s72, 10, 0
    s_sub_u32 s86, s86, s72
    v_mov_b32 v5, 153856
    v_mov_b32 v12, 0
    v_mov_b32 v13, 0
    v_lshl_add_u32 v5, v1, 3, v5
    s_mov_b64 exec, 0xfff
    ds_write_b64 v5, v[12:13]
    ds_write_b64 v5, v[12:13] offset:8192
    s_mov_b64 exec, 0xffff
    v_lshlrev_b32 v5, 3, v1
    v_add_u32 v5, 19456, v5
    ds_write_b64 v5, v[12:13] offset:0
    ds_write_b64 v5, v[12:13] offset:19712
    ds_write_b64 v5, v[12:13] offset:39424
    ds_write_b64 v5, v[12:13] offset:59136
    s_mov_b64 exec, -1
    s_waitcnt lgkmcnt(0)
    s_barrier
    s_add_u32 s4, s66, 0xd1d000
    s_addc_u32 s5, s67, 0
    s_load_dword s71, s[4:5], 0
    s_mov_b32 s8, s66
    s_and_b32 s9, s67, 0xffff
    s_mov_b32 s10, 0xd20000
    s_mov_b32 s11, 0x00020000
    s_mov_b32 s12, s36
    s_and_b32 s13, s37, 0xffff
    s_mov_b32 s14, 0x280000
    s_mov_b32 s15, 0x00020000
    s_cmp_ge_u32 s68, 4
    s_cbranch_scc1 L_gemm
    s_cmp_eq_u32 s68, 3
    s_cbranch_scc1 L_load
    s_add_u32 s84, s6, s68
    s_setprio 2
    s_mov_b32 s16, s38
    s_and_b32 s17, s39, 0xffff
    s_mov_b32 s18, 0x28000
    s_mov_b32 s19, 0x00020000
    s_mov_b32 s20, s40
    s_and_b32 s21, s41, 0xffff
    s_mov_b32 s22, 0x28000
    s_mov_b32 s23, 0x00020000
    s_mov_b32 s24, s42
    s_and_b32 s25, s43, 0xffff
    s_mov_b32 s26, 0x28000
    s_mov_b32 s27, 0x00020000
    s_mov_b32 s28, s44
    s_and_b32 s29, s45, 0xffff
    s_mov_b32 s30, 0x28000
    s_mov_b32 s31, 0x00020000
    s_mov_b32 s32, s46
    s_and_b32 s33, s47, 0xffff
    s_mov_b32 s34, 0x500
    s_mov_b32 s35, 0x00020000
    v_lshlrev_b32 v5, 2, v1
    s_lshl_b32 s72, s84, 8
    buffer_load_dword v12, v5, s[16:19], s72 offen
    buffer_load_dword v13, v5, s[20:23], s72 offen
    buffer_load_dword v14, v5, s[24:27], s72 offen
    buffer_load_dword v15, v5, s[28:31], s72 offen
    s_lshl_b32 s72, s84, 1
    v_mov_b32 v6, 0
    buffer_load_ushort v16, v6, s[32:35], s72 offen
    s_mul_i32 s72, s68, 16896
    s_add_u32 s72, s72, 78848
    v_lshlrev_b32 v17, 3, v1
    v_add_u32 v17, s72, v17
    v_mul_u32_u24 v18, 528, v2
    v_lshl_add_u32 v18, v3, 4, v18
    v_add_u32 v18, s72, v18
    s_waitcnt vmcnt(0) lgkmcnt(0)
    v_lshlrev_b32 v16, 16, v16
    v_mul_f32 v16, 0x3fb8aa3b, v16
    v_exp_f32 v16, v16
    v_lshlrev_b32 v20, 16, v12
    v_and_b32 v21, s92, v12
    v_cvt_pk_bf16_f32 v16, v16, v16
    v_mul_f32 v20, 0x3fb8aa3b, v20
    v_mul_f32 v21, 0x3fb8aa3b, v21
    v_and_b32 v16, s92, v16
    v_exp_f32 v20, v20
    v_exp_f32 v21, v21
    v_lshlrev_b32 v22, 16, v13
    v_and_b32 v23, s92, v13
    v_cvt_pk_bf16_f32 v5, v20, v21
    v_lshlrev_b32 v20, 16, v5
    v_and_b32 v21, s92, v5
    v_mul_f32 v20, v20, v16
    v_mul_f32 v22, v22, v16
    v_mul_f32 v21, v21, v16
    v_mul_f32 v23, v23, v16
    v_mul_f32 v20, 0xbfb8aa3b, v20
    v_mul_f32 v22, 0x3e22f983, v22
    v_mul_f32 v21, 0xbfb8aa3b, v21
    v_mul_f32 v23, 0x3e22f983, v23
    v_lshlrev_b32 v24, 16, v14
    v_lshlrev_b32 v25, 16, v15
    v_and_b32 v26, s92, v14
    v_and_b32 v27, s92, v15
    v_max3_f32 v28, abs(v24), abs(v25), abs(v26)
    v_max3_f32 v28, abs(v27), v28, v28
    s_nop 1
    v_max_f32_dpp v28, v28, v28 row_ror:8 row_mask:0xf bank_mask:0xf
    s_nop 1
    v_max_f32_dpp v28, v28, v28 row_ror:4 row_mask:0xf bank_mask:0xf
    s_nop 1
    v_max_f32_dpp v28, v28, v28 row_ror:2 row_mask:0xf bank_mask:0xf
    s_nop 1
    v_max_f32_dpp v28, v28, v28 row_ror:1 row_mask:0xf bank_mask:0xf
    v_mov_b32 v5, v28
    s_nop 1
    v_permlane16_swap_b32 v28, v5
    v_max_f32 v28, v28, v5
    v_mov_b32 v5, v28
    s_nop 1
    v_permlane32_swap_b32 v28, v5
    v_max_f32 v28, v28, v5
    v_frexp_exp_i32_f32 v28, v28
    v_sub_u32 v5, 14, v28
    v_ldexp_f32 v24, v24, v5
    v_ldexp_f32 v25, v25, v5
    v_ldexp_f32 v26, v26, v5
    v_ldexp_f32 v27, v27, v5
    v_subrev_u32 v28, 13, v28
    v_ldexp_f32 v16, v16, v28
    v_mul_f32 v30, 0x41000000, v20
    v_mul_f32 v32, 0x41000000, v22
    v_mul_f32 v31, 0x41000000, v21
    v_mul_f32 v33, 0x41000000, v23
    v_exp_f32 v30, v30
    v_fract_f32 v32, v32
    v_exp_f32 v31, v31
    v_fract_f32 v33, v33
    v_cos_f32 v36, v32
    v_sin_f32 v37, v32
    v_cos_f32 v38, v33
    v_sin_f32 v39, v33
    v_pk_mul_f32 v[36:37], v[36:37], v[30:31] op_sel:[0,0] op_sel_hi:[1,0]
    v_pk_mul_f32 v[38:39], v[38:39], v[30:31] op_sel:[0,1] op_sel_hi:[1,1]
    v_mul_f32 v30, 1.0, v20
    v_mul_f32 v32, 1.0, v22
    v_mul_f32 v31, 1.0, v21
    v_mul_f32 v33, 1.0, v23
    v_exp_f32 v30, v30
    v_fract_f32 v32, v32
    v_exp_f32 v31, v31
    v_fract_f32 v33, v33
    v_cos_f32 v40, v32
    v_sin_f32 v41, v32
    v_cos_f32 v42, v33
    v_sin_f32 v43, v33
    v_pk_mul_f32 v[40:41], v[40:41], v[30:31] op_sel:[0,0] op_sel_hi:[1,0]
    v_pk_mul_f32 v[42:43], v[42:43], v[30:31] op_sel:[0,1] op_sel_hi:[1,1]
    v_mul_f32 v30, 0x43800000, v20
    v_mul_f32 v32, 0x43800000, v22
    v_mul_f32 v31, 0x43800000, v21
    v_mul_f32 v33, 0x43800000, v23
    v_exp_f32 v30, v30
    v_fract_f32 v32, v32
    v_exp_f32 v31, v31
    v_fract_f32 v33, v33
    v_cos_f32 v44, v32
    v_sin_f32 v45, v32
    v_cos_f32 v46, v33
    v_sin_f32 v47, v33
    v_pk_mul_f32 v[44:45], v[44:45], v[30:31] op_sel:[0,0] op_sel_hi:[1,0]
    v_pk_mul_f32 v[46:47], v[46:47], v[30:31] op_sel:[0,1] op_sel_hi:[1,1]
    v_mov_b32 v48, 0x3c00
    v_mov_b32 v49, 0x3c00
    v_cvt_pk_f16_f32 v50, v36, v37
    v_cvt_pk_f16_f32 v51, v38, v39
    v_pk_mul_f32 v[176:177], v[36:37], v[36:37] op_sel:[0,0] op_sel_hi:[1,0]
    v_pk_mul_f32 v[178:179], v[38:39], v[38:39] op_sel:[0,0] op_sel_hi:[1,0]
    v_pk_fma_f32 v[176:177], v[36:37], v[36:37], v[176:177] op_sel:[1,1,0] op_sel_hi:[0,1,1] neg_lo:[1,0,0]
    v_pk_fma_f32 v[178:179], v[38:39], v[38:39], v[178:179] op_sel:[1,1,0] op_sel_hi:[0,1,1] neg_lo:[1,0,0]
    v_cvt_pk_f16_f32 v52, v176, v177
    v_cvt_pk_f16_f32 v53, v178, v179
    v_pk_mul_f32 v[180:181], v[176:177], v[36:37] op_sel:[0,0] op_sel_hi:[1,0]
    v_pk_mul_f32 v[182:183], v[178:179], v[38:39] op_sel:[0,0] op_sel_hi:[1,0]
    v_pk_fma_f32 v[180:181], v[176:177], v[36:37], v[180:181] op_sel:[1,1,0] op_sel_hi:[0,1,1] neg_lo:[1,0,0]
    v_pk_fma_f32 v[182:183], v[178:179], v[38:39], v[182:183] op_sel:[1,1,0] op_sel_hi:[0,1,1] neg_lo:[1,0,0]
    v_cvt_pk_f16_f32 v54, v180, v181
    v_cvt_pk_f16_f32 v55, v182, v183
    v_pk_mul_f32 v[176:177], v[180:181], v[36:37] op_sel:[0,0] op_sel_hi:[1,0]
    v_pk_mul_f32 v[178:179], v[182:183], v[38:39] op_sel:[0,0] op_sel_hi:[1,0]
    v_pk_fma_f32 v[176:177], v[180:181], v[36:37], v[176:177] op_sel:[1,1,0] op_sel_hi:[0,1,1] neg_lo:[1,0,0]
    v_pk_fma_f32 v[178:179], v[182:183], v[38:39], v[178:179] op_sel:[1,1,0] op_sel_hi:[0,1,1] neg_lo:[1,0,0]
    v_cvt_pk_f16_f32 v56, v176, v177
    v_cvt_pk_f16_f32 v57, v178, v179
    v_pk_mul_f32 v[180:181], v[176:177], v[36:37] op_sel:[0,0] op_sel_hi:[1,0]
    v_pk_mul_f32 v[182:183], v[178:179], v[38:39] op_sel:[0,0] op_sel_hi:[1,0]
    v_pk_fma_f32 v[180:181], v[176:177], v[36:37], v[180:181] op_sel:[1,1,0] op_sel_hi:[0,1,1] neg_lo:[1,0,0]
    v_pk_fma_f32 v[182:183], v[178:179], v[38:39], v[182:183] op_sel:[1,1,0] op_sel_hi:[0,1,1] neg_lo:[1,0,0]
    v_cvt_pk_f16_f32 v58, v180, v181
    v_cvt_pk_f16_f32 v59, v182, v183
    v_pk_mul_f32 v[176:177], v[180:181], v[36:37] op_sel:[0,0] op_sel_hi:[1,0]
    v_pk_mul_f32 v[178:179], v[182:183], v[38:39] op_sel:[0,0] op_sel_hi:[1,0]
    v_pk_fma_f32 v[176:177], v[180:181], v[36:37], v[176:177] op_sel:[1,1,0] op_sel_hi:[0,1,1] neg_lo:[1,0,0]
    v_pk_fma_f32 v[178:179], v[182:183], v[38:39], v[178:179] op_sel:[1,1,0] op_sel_hi:[0,1,1] neg_lo:[1,0,0]
    v_cvt_pk_f16_f32 v60, v176, v177
    v_cvt_pk_f16_f32 v61, v178, v179
    v_pk_mul_f32 v[180:181], v[176:177], v[36:37] op_sel:[0,0] op_sel_hi:[1,0]
    v_pk_mul_f32 v[182:183], v[178:179], v[38:39] op_sel:[0,0] op_sel_hi:[1,0]
    v_pk_fma_f32 v[180:181], v[176:177], v[36:37], v[180:181] op_sel:[1,1,0] op_sel_hi:[0,1,1] neg_lo:[1,0,0]
    v_pk_fma_f32 v[182:183], v[178:179], v[38:39], v[182:183] op_sel:[1,1,0] op_sel_hi:[0,1,1] neg_lo:[1,0,0]
    v_cvt_pk_f16_f32 v62, v180, v181
    v_cvt_pk_f16_f32 v63, v182, v183
    ds_write_b64 v17, v[48:49] offset:0
    ds_write_b64 v17, v[50:51] offset:528
    ds_write_b64 v17, v[52:53] offset:1056
    ds_write_b64 v17, v[54:55] offset:1584
    ds_write_b64 v17, v[56:57] offset:2112
    ds_write_b64 v17, v[58:59] offset:2640
    ds_write_b64 v17, v[60:61] offset:3168
    ds_write_b64 v17, v[62:63] offset:3696
    v_pk_mul_f32 v[176:177], v[180:181], v[36:37] op_sel:[0,0] op_sel_hi:[1,0]
    v_pk_mul_f32 v[178:179], v[182:183], v[38:39] op_sel:[0,0] op_sel_hi:[1,0]
    v_pk_fma_f32 v[176:177], v[180:181], v[36:37], v[176:177] op_sel:[1,1,0] op_sel_hi:[0,1,1] neg_lo:[1,0,0]
    v_pk_fma_f32 v[178:179], v[182:183], v[38:39], v[178:179] op_sel:[1,1,0] op_sel_hi:[0,1,1] neg_lo:[1,0,0]
    v_cvt_pk_f16_f32 v64, v176, v177
    v_cvt_pk_f16_f32 v65, v178, v179
    v_pk_mul_f32 v[180:181], v[176:177], v[36:37] op_sel:[0,0] op_sel_hi:[1,0]
    v_pk_mul_f32 v[182:183], v[178:179], v[38:39] op_sel:[0,0] op_sel_hi:[1,0]
    v_pk_fma_f32 v[180:181], v[176:177], v[36:37], v[180:181] op_sel:[1,1,0] op_sel_hi:[0,1,1] neg_lo:[1,0,0]
    v_pk_fma_f32 v[182:183], v[178:179], v[38:39], v[182:183] op_sel:[1,1,0] op_sel_hi:[0,1,1] neg_lo:[1,0,0]
    v_cvt_pk_f16_f32 v66, v180, v181
    v_cvt_pk_f16_f32 v67, v182, v183
    v_pk_mul_f32 v[176:177], v[180:181], v[36:37] op_sel:[0,0] op_sel_hi:[1,0]
    v_pk_mul_f32 v[178:179], v[182:183], v[38:39] op_sel:[0,0] op_sel_hi:[1,0]
    v_pk_fma_f32 v[176:177], v[180:181], v[36:37], v[176:177] op_sel:[1,1,0] op_sel_hi:[0,1,1] neg_lo:[1,0,0]
    v_pk_fma_f32 v[178:179], v[182:183], v[38:39], v[178:179] op_sel:[1,1,0] op_sel_hi:[0,1,1] neg_lo:[1,0,0]
    v_cvt_pk_f16_f32 v68, v176, v177
    v_cvt_pk_f16_f32 v69, v178, v179
    v_pk_mul_f32 v[180:181], v[176:177], v[36:37] op_sel:[0,0] op_sel_hi:[1,0]
    v_pk_mul_f32 v[182:183], v[178:179], v[38:39] op_sel:[0,0] op_sel_hi:[1,0]
    v_pk_fma_f32 v[180:181], v[176:177], v[36:37], v[180:181] op_sel:[1,1,0] op_sel_hi:[0,1,1] neg_lo:[1,0,0]
    v_pk_fma_f32 v[182:183], v[178:179], v[38:39], v[182:183] op_sel:[1,1,0] op_sel_hi:[0,1,1] neg_lo:[1,0,0]
    v_cvt_pk_f16_f32 v70, v180, v181
    v_cvt_pk_f16_f32 v71, v182, v183
    v_pk_mul_f32 v[176:177], v[180:181], v[36:37] op_sel:[0,0] op_sel_hi:[1,0]
    v_pk_mul_f32 v[178:179], v[182:183], v[38:39] op_sel:[0,0] op_sel_hi:[1,0]
    v_pk_fma_f32 v[176:177], v[180:181], v[36:37], v[176:177] op_sel:[1,1,0] op_sel_hi:[0,1,1] neg_lo:[1,0,0]
    v_pk_fma_f32 v[178:179], v[182:183], v[38:39], v[178:179] op_sel:[1,1,0] op_sel_hi:[0,1,1] neg_lo:[1,0,0]
    v_cvt_pk_f16_f32 v72, v176, v177
    v_cvt_pk_f16_f32 v73, v178, v179
    v_pk_mul_f32 v[180:181], v[176:177], v[36:37] op_sel:[0,0] op_sel_hi:[1,0]
    v_pk_mul_f32 v[182:183], v[178:179], v[38:39] op_sel:[0,0] op_sel_hi:[1,0]
    v_pk_fma_f32 v[180:181], v[176:177], v[36:37], v[180:181] op_sel:[1,1,0] op_sel_hi:[0,1,1] neg_lo:[1,0,0]
    v_pk_fma_f32 v[182:183], v[178:179], v[38:39], v[182:183] op_sel:[1,1,0] op_sel_hi:[0,1,1] neg_lo:[1,0,0]
    v_cvt_pk_f16_f32 v74, v180, v181
    v_cvt_pk_f16_f32 v75, v182, v183
    v_pk_mul_f32 v[176:177], v[180:181], v[36:37] op_sel:[0,0] op_sel_hi:[1,0]
    v_pk_mul_f32 v[178:179], v[182:183], v[38:39] op_sel:[0,0] op_sel_hi:[1,0]
    v_pk_fma_f32 v[176:177], v[180:181], v[36:37], v[176:177] op_sel:[1,1,0] op_sel_hi:[0,1,1] neg_lo:[1,0,0]
    v_pk_fma_f32 v[178:179], v[182:183], v[38:39], v[178:179] op_sel:[1,1,0] op_sel_hi:[0,1,1] neg_lo:[1,0,0]
    v_cvt_pk_f16_f32 v76, v176, v177
    v_cvt_pk_f16_f32 v77, v178, v179
    v_pk_mul_f32 v[180:181], v[176:177], v[36:37] op_sel:[0,0] op_sel_hi:[1,0]
    v_pk_mul_f32 v[182:183], v[178:179], v[38:39] op_sel:[0,0] op_sel_hi:[1,0]
    v_pk_fma_f32 v[180:181], v[176:177], v[36:37], v[180:181] op_sel:[1,1,0] op_sel_hi:[0,1,1] neg_lo:[1,0,0]
    v_pk_fma_f32 v[182:183], v[178:179], v[38:39], v[182:183] op_sel:[1,1,0] op_sel_hi:[0,1,1] neg_lo:[1,0,0]
    v_cvt_pk_f16_f32 v78, v180, v181
    v_cvt_pk_f16_f32 v79, v182, v183
    ds_write_b64 v17, v[64:65] offset:4224
    ds_write_b64 v17, v[66:67] offset:4752
    ds_write_b64 v17, v[68:69] offset:5280
    ds_write_b64 v17, v[70:71] offset:5808
    ds_write_b64 v17, v[72:73] offset:6336
    ds_write_b64 v17, v[74:75] offset:6864
    ds_write_b64 v17, v[76:77] offset:7392
    ds_write_b64 v17, v[78:79] offset:7920
    v_pk_mul_f32 v[176:177], v[180:181], v[36:37] op_sel:[0,0] op_sel_hi:[1,0]
    v_pk_mul_f32 v[178:179], v[182:183], v[38:39] op_sel:[0,0] op_sel_hi:[1,0]
    v_pk_fma_f32 v[176:177], v[180:181], v[36:37], v[176:177] op_sel:[1,1,0] op_sel_hi:[0,1,1] neg_lo:[1,0,0]
    v_pk_fma_f32 v[178:179], v[182:183], v[38:39], v[178:179] op_sel:[1,1,0] op_sel_hi:[0,1,1] neg_lo:[1,0,0]
    v_cvt_pk_f16_f32 v80, v176, v177
    v_cvt_pk_f16_f32 v81, v178, v179
    v_pk_mul_f32 v[180:181], v[176:177], v[36:37] op_sel:[0,0] op_sel_hi:[1,0]
    v_pk_mul_f32 v[182:183], v[178:179], v[38:39] op_sel:[0,0] op_sel_hi:[1,0]
    v_pk_fma_f32 v[180:181], v[176:177], v[36:37], v[180:181] op_sel:[1,1,0] op_sel_hi:[0,1,1] neg_lo:[1,0,0]
    v_pk_fma_f32 v[182:183], v[178:179], v[38:39], v[182:183] op_sel:[1,1,0] op_sel_hi:[0,1,1] neg_lo:[1,0,0]
    v_cvt_pk_f16_f32 v82, v180, v181
    v_cvt_pk_f16_f32 v83, v182, v183
    v_pk_mul_f32 v[176:177], v[180:181], v[36:37] op_sel:[0,0] op_sel_hi:[1,0]
    v_pk_mul_f32 v[178:179], v[182:183], v[38:39] op_sel:[0,0] op_sel_hi:[1,0]
    v_pk_fma_f32 v[176:177], v[180:181], v[36:37], v[176:177] op_sel:[1,1,0] op_sel_hi:[0,1,1] neg_lo:[1,0,0]
    v_pk_fma_f32 v[178:179], v[182:183], v[38:39], v[178:179] op_sel:[1,1,0] op_sel_hi:[0,1,1] neg_lo:[1,0,0]
    v_cvt_pk_f16_f32 v84, v176, v177
    v_cvt_pk_f16_f32 v85, v178, v179
    v_pk_mul_f32 v[180:181], v[176:177], v[36:37] op_sel:[0,0] op_sel_hi:[1,0]
    v_pk_mul_f32 v[182:183], v[178:179], v[38:39] op_sel:[0,0] op_sel_hi:[1,0]
    v_pk_fma_f32 v[180:181], v[176:177], v[36:37], v[180:181] op_sel:[1,1,0] op_sel_hi:[0,1,1] neg_lo:[1,0,0]
    v_pk_fma_f32 v[182:183], v[178:179], v[38:39], v[182:183] op_sel:[1,1,0] op_sel_hi:[0,1,1] neg_lo:[1,0,0]
    v_cvt_pk_f16_f32 v86, v180, v181
    v_cvt_pk_f16_f32 v87, v182, v183
    v_pk_mul_f32 v[176:177], v[180:181], v[36:37] op_sel:[0,0] op_sel_hi:[1,0]
    v_pk_mul_f32 v[178:179], v[182:183], v[38:39] op_sel:[0,0] op_sel_hi:[1,0]
    v_pk_fma_f32 v[176:177], v[180:181], v[36:37], v[176:177] op_sel:[1,1,0] op_sel_hi:[0,1,1] neg_lo:[1,0,0]
    v_pk_fma_f32 v[178:179], v[182:183], v[38:39], v[178:179] op_sel:[1,1,0] op_sel_hi:[0,1,1] neg_lo:[1,0,0]
    v_cvt_pk_f16_f32 v88, v176, v177
    v_cvt_pk_f16_f32 v89, v178, v179
    v_pk_mul_f32 v[180:181], v[176:177], v[36:37] op_sel:[0,0] op_sel_hi:[1,0]
    v_pk_mul_f32 v[182:183], v[178:179], v[38:39] op_sel:[0,0] op_sel_hi:[1,0]
    v_pk_fma_f32 v[180:181], v[176:177], v[36:37], v[180:181] op_sel:[1,1,0] op_sel_hi:[0,1,1] neg_lo:[1,0,0]
    v_pk_fma_f32 v[182:183], v[178:179], v[38:39], v[182:183] op_sel:[1,1,0] op_sel_hi:[0,1,1] neg_lo:[1,0,0]
    v_cvt_pk_f16_f32 v90, v180, v181
    v_cvt_pk_f16_f32 v91, v182, v183
    v_pk_mul_f32 v[176:177], v[180:181], v[36:37] op_sel:[0,0] op_sel_hi:[1,0]
    v_pk_mul_f32 v[178:179], v[182:183], v[38:39] op_sel:[0,0] op_sel_hi:[1,0]
    v_pk_fma_f32 v[176:177], v[180:181], v[36:37], v[176:177] op_sel:[1,1,0] op_sel_hi:[0,1,1] neg_lo:[1,0,0]
    v_pk_fma_f32 v[178:179], v[182:183], v[38:39], v[178:179] op_sel:[1,1,0] op_sel_hi:[0,1,1] neg_lo:[1,0,0]
    v_cvt_pk_f16_f32 v92, v176, v177
    v_cvt_pk_f16_f32 v93, v178, v179
    v_pk_mul_f32 v[180:181], v[176:177], v[36:37] op_sel:[0,0] op_sel_hi:[1,0]
    v_pk_mul_f32 v[182:183], v[178:179], v[38:39] op_sel:[0,0] op_sel_hi:[1,0]
    v_pk_fma_f32 v[180:181], v[176:177], v[36:37], v[180:181] op_sel:[1,1,0] op_sel_hi:[0,1,1] neg_lo:[1,0,0]
    v_pk_fma_f32 v[182:183], v[178:179], v[38:39], v[182:183] op_sel:[1,1,0] op_sel_hi:[0,1,1] neg_lo:[1,0,0]
    v_cvt_pk_f16_f32 v94, v180, v181
    v_cvt_pk_f16_f32 v95, v182, v183
    ds_write_b64 v17, v[80:81] offset:8448
    ds_write_b64 v17, v[82:83] offset:8976
    ds_write_b64 v17, v[84:85] offset:9504
    ds_write_b64 v17, v[86:87] offset:10032
    ds_write_b64 v17, v[88:89] offset:10560
    ds_write_b64 v17, v[90:91] offset:11088
    ds_write_b64 v17, v[92:93] offset:11616
    ds_write_b64 v17, v[94:95] offset:12144
    v_pk_mul_f32 v[176:177], v[180:181], v[36:37] op_sel:[0,0] op_sel_hi:[1,0]
    v_pk_mul_f32 v[178:179], v[182:183], v[38:39] op_sel:[0,0] op_sel_hi:[1,0]
    v_pk_fma_f32 v[176:177], v[180:181], v[36:37], v[176:177] op_sel:[1,1,0] op_sel_hi:[0,1,1] neg_lo:[1,0,0]
    v_pk_fma_f32 v[178:179], v[182:183], v[38:39], v[178:179] op_sel:[1,1,0] op_sel_hi:[0,1,1] neg_lo:[1,0,0]
    v_cvt_pk_f16_f32 v96, v176, v177
    v_cvt_pk_f16_f32 v97, v178, v179
    v_pk_mul_f32 v[180:181], v[176:177], v[36:37] op_sel:[0,0] op_sel_hi:[1,0]
    v_pk_mul_f32 v[182:183], v[178:179], v[38:39] op_sel:[0,0] op_sel_hi:[1,0]
    v_pk_fma_f32 v[180:181], v[176:177], v[36:37], v[180:181] op_sel:[1,1,0] op_sel_hi:[0,1,1] neg_lo:[1,0,0]
    v_pk_fma_f32 v[182:183], v[178:179], v[38:39], v[182:183] op_sel:[1,1,0] op_sel_hi:[0,1,1] neg_lo:[1,0,0]
    v_cvt_pk_f16_f32 v98, v180, v181
    v_cvt_pk_f16_f32 v99, v182, v183
    v_pk_mul_f32 v[176:177], v[180:181], v[36:37] op_sel:[0,0] op_sel_hi:[1,0]
    v_pk_mul_f32 v[178:179], v[182:183], v[38:39] op_sel:[0,0] op_sel_hi:[1,0]
    v_pk_fma_f32 v[176:177], v[180:181], v[36:37], v[176:177] op_sel:[1,1,0] op_sel_hi:[0,1,1] neg_lo:[1,0,0]
    v_pk_fma_f32 v[178:179], v[182:183], v[38:39], v[178:179] op_sel:[1,1,0] op_sel_hi:[0,1,1] neg_lo:[1,0,0]
    v_cvt_pk_f16_f32 v100, v176, v177
    v_cvt_pk_f16_f32 v101, v178, v179
    v_pk_mul_f32 v[180:181], v[176:177], v[36:37] op_sel:[0,0] op_sel_hi:[1,0]
    v_pk_mul_f32 v[182:183], v[178:179], v[38:39] op_sel:[0,0] op_sel_hi:[1,0]
    v_pk_fma_f32 v[180:181], v[176:177], v[36:37], v[180:181] op_sel:[1,1,0] op_sel_hi:[0,1,1] neg_lo:[1,0,0]
    v_pk_fma_f32 v[182:183], v[178:179], v[38:39], v[182:183] op_sel:[1,1,0] op_sel_hi:[0,1,1] neg_lo:[1,0,0]
    v_cvt_pk_f16_f32 v102, v180, v181
    v_cvt_pk_f16_f32 v103, v182, v183
    v_pk_mul_f32 v[176:177], v[180:181], v[36:37] op_sel:[0,0] op_sel_hi:[1,0]
    v_pk_mul_f32 v[178:179], v[182:183], v[38:39] op_sel:[0,0] op_sel_hi:[1,0]
    v_pk_fma_f32 v[176:177], v[180:181], v[36:37], v[176:177] op_sel:[1,1,0] op_sel_hi:[0,1,1] neg_lo:[1,0,0]
    v_pk_fma_f32 v[178:179], v[182:183], v[38:39], v[178:179] op_sel:[1,1,0] op_sel_hi:[0,1,1] neg_lo:[1,0,0]
    v_cvt_pk_f16_f32 v104, v176, v177
    v_cvt_pk_f16_f32 v105, v178, v179
    v_pk_mul_f32 v[180:181], v[176:177], v[36:37] op_sel:[0,0] op_sel_hi:[1,0]
    v_pk_mul_f32 v[182:183], v[178:179], v[38:39] op_sel:[0,0] op_sel_hi:[1,0]
    v_pk_fma_f32 v[180:181], v[176:177], v[36:37], v[180:181] op_sel:[1,1,0] op_sel_hi:[0,1,1] neg_lo:[1,0,0]
    v_pk_fma_f32 v[182:183], v[178:179], v[38:39], v[182:183] op_sel:[1,1,0] op_sel_hi:[0,1,1] neg_lo:[1,0,0]
    v_cvt_pk_f16_f32 v106, v180, v181
    v_cvt_pk_f16_f32 v107, v182, v183
    v_pk_mul_f32 v[176:177], v[180:181], v[36:37] op_sel:[0,0] op_sel_hi:[1,0]
    v_pk_mul_f32 v[178:179], v[182:183], v[38:39] op_sel:[0,0] op_sel_hi:[1,0]
    v_pk_fma_f32 v[176:177], v[180:181], v[36:37], v[176:177] op_sel:[1,1,0] op_sel_hi:[0,1,1] neg_lo:[1,0,0]
    v_pk_fma_f32 v[178:179], v[182:183], v[38:39], v[178:179] op_sel:[1,1,0] op_sel_hi:[0,1,1] neg_lo:[1,0,0]
    v_cvt_pk_f16_f32 v108, v176, v177
    v_cvt_pk_f16_f32 v109, v178, v179
    v_pk_mul_f32 v[180:181], v[176:177], v[36:37] op_sel:[0,0] op_sel_hi:[1,0]
    v_pk_mul_f32 v[182:183], v[178:179], v[38:39] op_sel:[0,0] op_sel_hi:[1,0]
    v_pk_fma_f32 v[180:181], v[176:177], v[36:37], v[180:181] op_sel:[1,1,0] op_sel_hi:[0,1,1] neg_lo:[1,0,0]
    v_pk_fma_f32 v[182:183], v[178:179], v[38:39], v[182:183] op_sel:[1,1,0] op_sel_hi:[0,1,1] neg_lo:[1,0,0]
    v_cvt_pk_f16_f32 v110, v180, v181
    v_cvt_pk_f16_f32 v111, v182, v183
    ds_write_b64 v17, v[96:97] offset:12672
    ds_write_b64 v17, v[98:99] offset:13200
    ds_write_b64 v17, v[100:101] offset:13728
    ds_write_b64 v17, v[102:103] offset:14256
    ds_write_b64 v17, v[104:105] offset:14784
    ds_write_b64 v17, v[106:107] offset:15312
    ds_write_b64 v17, v[108:109] offset:15840
    ds_write_b64 v17, v[110:111] offset:16368
    ds_read_b128 v[112:115], v18 offset:0
    ds_read_b128 v[116:119], v18 offset:32
    ds_read_b128 v[120:123], v18 offset:64
    ds_read_b128 v[124:127], v18 offset:96
    ds_read_b128 v[128:131], v18 offset:128
    ds_read_b128 v[132:135], v18 offset:160
    ds_read_b128 v[136:139], v18 offset:192
    ds_read_b128 v[140:143], v18 offset:224
    ds_read_b128 v[144:147], v18 offset:256
    ds_read_b128 v[148:151], v18 offset:288
    ds_read_b128 v[152:155], v18 offset:320
    ds_read_b128 v[156:159], v18 offset:352
    ds_read_b128 v[160:163], v18 offset:384
    ds_read_b128 v[164:167], v18 offset:416
    ds_read_b128 v[168:171], v18 offset:448
    ds_read_b128 v[172:175], v18 offset:480
    v_cvt_pk_f16_f32 v48, v24, -v25
    v_cvt_pk_f16_f32 v49, v26, -v27
    v_pk_mul_f32 v[176:177], v[24:25], v[40:41] op_sel:[0,0] op_sel_hi:[1,0]
    v_pk_mul_f32 v[178:179], v[26:27], v[42:43] op_sel:[0,0] op_sel_hi:[1,0]
    v_pk_fma_f32 v[176:177], v[24:25], v[40:41], v[176:177] op_sel:[1,1,0] op_sel_hi:[0,1,1] neg_lo:[1,0,0]
    v_pk_fma_f32 v[178:179], v[26:27], v[42:43], v[178:179] op_sel:[1,1,0] op_sel_hi:[0,1,1] neg_lo:[1,0,0]
    v_cvt_pk_f16_f32 v50, v176, -v177
    v_cvt_pk_f16_f32 v51, v178, -v179
    v_pk_mul_f32 v[184:185], v[176:177], v[40:41] op_sel:[0,0] op_sel_hi:[1,0]
    v_pk_mul_f32 v[186:187], v[178:179], v[42:43] op_sel:[0,0] op_sel_hi:[1,0]
    v_pk_fma_f32 v[184:185], v[176:177], v[40:41], v[184:185] op_sel:[1,1,0] op_sel_hi:[0,1,1] neg_lo:[1,0,0]
    v_pk_fma_f32 v[186:187], v[178:179], v[42:43], v[186:187] op_sel:[1,1,0] op_sel_hi:[0,1,1] neg_lo:[1,0,0]
    v_cvt_pk_f16_f32 v52, v184, -v185
    v_cvt_pk_f16_f32 v53, v186, -v187
    v_pk_mul_f32 v[176:177], v[184:185], v[40:41] op_sel:[0,0] op_sel_hi:[1,0]
    v_pk_mul_f32 v[178:179], v[186:187], v[42:43] op_sel:[0,0] op_sel_hi:[1,0]
    v_pk_fma_f32 v[176:177], v[184:185], v[40:41], v[176:177] op_sel:[1,1,0] op_sel_hi:[0,1,1] neg_lo:[1,0,0]
    v_pk_fma_f32 v[178:179], v[186:187], v[42:43], v[178:179] op_sel:[1,1,0] op_sel_hi:[0,1,1] neg_lo:[1,0,0]
    v_cvt_pk_f16_f32 v54, v176, -v177
    v_cvt_pk_f16_f32 v55, v178, -v179
    v_pk_mul_f32 v[188:189], v[176:177], v[40:41] op_sel:[0,0] op_sel_hi:[1,0]
    v_pk_mul_f32 v[190:191], v[178:179], v[42:43] op_sel:[0,0] op_sel_hi:[1,0]
    v_pk_fma_f32 v[188:189], v[176:177], v[40:41], v[188:189] op_sel:[1,1,0] op_sel_hi:[0,1,1] neg_lo:[1,0,0]
    v_pk_fma_f32 v[190:191], v[178:179], v[42:43], v[190:191] op_sel:[1,1,0] op_sel_hi:[0,1,1] neg_lo:[1,0,0]
    v_cvt_pk_f16_f32 v56, v188, -v189
    v_cvt_pk_f16_f32 v57, v190, -v191
    v_pk_mul_f32 v[176:177], v[188:189], v[40:41] op_sel:[0,0] op_sel_hi:[1,0]
    v_pk_mul_f32 v[178:179], v[190:191], v[42:43] op_sel:[0,0] op_sel_hi:[1,0]
    v_pk_fma_f32 v[176:177], v[188:189], v[40:41], v[176:177] op_sel:[1,1,0] op_sel_hi:[0,1,1] neg_lo:[1,0,0]
    v_pk_fma_f32 v[178:179], v[190:191], v[42:43], v[178:179] op_sel:[1,1,0] op_sel_hi:[0,1,1] neg_lo:[1,0,0]
    v_cvt_pk_f16_f32 v58, v176, -v177
    v_cvt_pk_f16_f32 v59, v178, -v179
    v_pk_mul_f32 v[192:193], v[176:177], v[40:41] op_sel:[0,0] op_sel_hi:[1,0]
    v_pk_mul_f32 v[194:195], v[178:179], v[42:43] op_sel:[0,0] op_sel_hi:[1,0]
    v_pk_fma_f32 v[192:193], v[176:177], v[40:41], v[192:193] op_sel:[1,1,0] op_sel_hi:[0,1,1] neg_lo:[1,0,0]
    v_pk_fma_f32 v[194:195], v[178:179], v[42:43], v[194:195] op_sel:[1,1,0] op_sel_hi:[0,1,1] neg_lo:[1,0,0]
    v_cvt_pk_f16_f32 v60, v192, -v193
    v_cvt_pk_f16_f32 v61, v194, -v195
    v_pk_mul_f32 v[176:177], v[192:193], v[40:41] op_sel:[0,0] op_sel_hi:[1,0]
    v_pk_mul_f32 v[178:179], v[194:195], v[42:43] op_sel:[0,0] op_sel_hi:[1,0]
    v_pk_fma_f32 v[176:177], v[192:193], v[40:41], v[176:177] op_sel:[1,1,0] op_sel_hi:[0,1,1] neg_lo:[1,0,0]
    v_pk_fma_f32 v[178:179], v[194:195], v[42:43], v[178:179] op_sel:[1,1,0] op_sel_hi:[0,1,1] neg_lo:[1,0,0]
    v_cvt_pk_f16_f32 v62, v176, -v177
    v_cvt_pk_f16_f32 v63, v178, -v179
    v_pk_mul_f32 v[196:197], v[24:25], v[36:37] op_sel:[0,0] op_sel_hi:[1,0]
    v_pk_mul_f32 v[198:199], v[26:27], v[38:39] op_sel:[0,0] op_sel_hi:[1,0]
    v_pk_fma_f32 v[196:197], v[24:25], v[36:37], v[196:197] op_sel:[1,1,0] op_sel_hi:[0,1,1] neg_lo:[1,0,0]
    v_pk_fma_f32 v[198:199], v[26:27], v[38:39], v[198:199] op_sel:[1,1,0] op_sel_hi:[0,1,1] neg_lo:[1,0,0]
    v_cvt_pk_f16_f32 v64, v196, -v197
    v_cvt_pk_f16_f32 v65, v198, -v199
    ds_write_b64 v17, v[48:49] offset:0
    ds_write_b64 v17, v[50:51] offset:528
    ds_write_b64 v17, v[52:53] offset:1056
    ds_write_b64 v17, v[54:55] offset:1584
    ds_write_b64 v17, v[56:57] offset:4224
    ds_write_b64 v17, v[58:59] offset:4752
    ds_write_b64 v17, v[60:61] offset:5280
    ds_write_b64 v17, v[62:63] offset:5808
    ds_write_b64 v17, v[64:65] offset:14256
    v_pk_mul_f32 v[180:181], v[24:25], v[44:45] op_sel:[0,0] op_sel_hi:[1,0]
    v_pk_mul_f32 v[182:183], v[26:27], v[46:47] op_sel:[0,0] op_sel_hi:[1,0]
    v_pk_fma_f32 v[180:181], v[24:25], v[44:45], v[180:181] op_sel:[1,1,0] op_sel_hi:[0,1,1] neg_lo:[1,0,0]
    v_pk_fma_f32 v[182:183], v[26:27], v[46:47], v[182:183] op_sel:[1,1,0] op_sel_hi:[0,1,1] neg_lo:[1,0,0]
    v_cvt_pk_f16_f32 v66, v180, -v181
    v_cvt_pk_f16_f32 v67, v182, -v183
    v_pk_mul_f32 v[176:177], v[184:185], v[44:45] op_sel:[0,0] op_sel_hi:[1,0]
    v_pk_mul_f32 v[178:179], v[186:187], v[46:47] op_sel:[0,0] op_sel_hi:[1,0]
    v_pk_fma_f32 v[176:177], v[184:185], v[44:45], v[176:177] op_sel:[1,1,0] op_sel_hi:[0,1,1] neg_lo:[1,0,0]
    v_pk_fma_f32 v[178:179], v[186:187], v[46:47], v[178:179] op_sel:[1,1,0] op_sel_hi:[0,1,1] neg_lo:[1,0,0]
    v_cvt_pk_f16_f32 v68, v176, -v177
    v_cvt_pk_f16_f32 v69, v178, -v179
    v_pk_mul_f32 v[200:201], v[188:189], v[44:45] op_sel:[0,0] op_sel_hi:[1,0]
    v_pk_mul_f32 v[202:203], v[190:191], v[46:47] op_sel:[0,0] op_sel_hi:[1,0]
    v_pk_fma_f32 v[200:201], v[188:189], v[44:45], v[200:201] op_sel:[1,1,0] op_sel_hi:[0,1,1] neg_lo:[1,0,0]
    v_pk_fma_f32 v[202:203], v[190:191], v[46:47], v[202:203] op_sel:[1,1,0] op_sel_hi:[0,1,1] neg_lo:[1,0,0]
    v_cvt_pk_f16_f32 v70, v200, -v201
    v_cvt_pk_f16_f32 v71, v202, -v203
    v_pk_mul_f32 v[176:177], v[192:193], v[44:45] op_sel:[0,0] op_sel_hi:[1,0]
    v_pk_mul_f32 v[178:179], v[194:195], v[46:47] op_sel:[0,0] op_sel_hi:[1,0]
    v_pk_fma_f32 v[176:177], v[192:193], v[44:45], v[176:177] op_sel:[1,1,0] op_sel_hi:[0,1,1] neg_lo:[1,0,0]
    v_pk_fma_f32 v[178:179], v[194:195], v[46:47], v[178:179] op_sel:[1,1,0] op_sel_hi:[0,1,1] neg_lo:[1,0,0]
    v_cvt_pk_f16_f32 v72, v176, -v177
    v_cvt_pk_f16_f32 v73, v178, -v179
    v_pk_mul_f32 v[204:205], v[196:197], v[44:45] op_sel:[0,0] op_sel_hi:[1,0]
    v_pk_mul_f32 v[206:207], v[198:199], v[46:47] op_sel:[0,0] op_sel_hi:[1,0]
    v_pk_fma_f32 v[204:205], v[196:197], v[44:45], v[204:205] op_sel:[1,1,0] op_sel_hi:[0,1,1] neg_lo:[1,0,0]
    v_pk_fma_f32 v[206:207], v[198:199], v[46:47], v[206:207] op_sel:[1,1,0] op_sel_hi:[0,1,1] neg_lo:[1,0,0]
    v_cvt_pk_f16_f32 v74, v204, -v205
    v_cvt_pk_f16_f32 v75, v206, -v207
    ds_write_b64 v17, v[66:67] offset:2112
    ds_write_b64 v17, v[66:67] offset:2640
    ds_write_b64 v17, v[68:69] offset:3168
    ds_write_b64 v17, v[70:71] offset:3696
    ds_write_b64 v17, v[70:71] offset:6336
    ds_write_b64 v17, v[70:71] offset:6864
    ds_write_b64 v17, v[72:73] offset:7392
    ds_write_b64 v17, v[74:75] offset:7920
    ds_write_b64 v17, v[74:75] offset:16368
    v_pk_mul_f32 v[24:25], v[180:181], v[44:45] op_sel:[0,0] op_sel_hi:[1,0]
    v_pk_mul_f32 v[26:27], v[182:183], v[46:47] op_sel:[0,0] op_sel_hi:[1,0]
    v_pk_fma_f32 v[24:25], v[180:181], v[44:45], v[24:25] op_sel:[1,1,0] op_sel_hi:[0,1,1] neg_lo:[1,0,0]
    v_pk_fma_f32 v[26:27], v[182:183], v[46:47], v[26:27] op_sel:[1,1,0] op_sel_hi:[0,1,1] neg_lo:[1,0,0]
    v_cvt_pk_f16_f32 v76, v24, -v25
    v_cvt_pk_f16_f32 v77, v26, -v27
    v_pk_mul_f32 v[188:189], v[200:201], v[44:45] op_sel:[0,0] op_sel_hi:[1,0]
    v_pk_mul_f32 v[190:191], v[202:203], v[46:47] op_sel:[0,0] op_sel_hi:[1,0]
    v_pk_fma_f32 v[188:189], v[200:201], v[44:45], v[188:189] op_sel:[1,1,0] op_sel_hi:[0,1,1] neg_lo:[1,0,0]
    v_pk_fma_f32 v[190:191], v[202:203], v[46:47], v[190:191] op_sel:[1,1,0] op_sel_hi:[0,1,1] neg_lo:[1,0,0]
    v_cvt_pk_f16_f32 v78, v188, -v189
    v_cvt_pk_f16_f32 v79, v190, -v191
    v_pk_mul_f32 v[196:197], v[204:205], v[44:45] op_sel:[0,0] op_sel_hi:[1,0]
    v_pk_mul_f32 v[198:199], v[206:207], v[46:47] op_sel:[0,0] op_sel_hi:[1,0]
    v_pk_fma_f32 v[196:197], v[204:205], v[44:45], v[196:197] op_sel:[1,1,0] op_sel_hi:[0,1,1] neg_lo:[1,0,0]
    v_pk_fma_f32 v[198:199], v[206:207], v[46:47], v[198:199] op_sel:[1,1,0] op_sel_hi:[0,1,1] neg_lo:[1,0,0]
    v_cvt_pk_f16_f32 v80, v196, -v197
    v_cvt_pk_f16_f32 v81, v198, -v199
    v_pk_mul_f32 v[180:181], v[24:25], v[44:45] op_sel:[0,0] op_sel_hi:[1,0]
    v_pk_mul_f32 v[182:183], v[26:27], v[46:47] op_sel:[0,0] op_sel_hi:[1,0]
    v_pk_fma_f32 v[180:181], v[24:25], v[44:45], v[180:181] op_sel:[1,1,0] op_sel_hi:[0,1,1] neg_lo:[1,0,0]
    v_pk_fma_f32 v[182:183], v[26:27], v[46:47], v[182:183] op_sel:[1,1,0] op_sel_hi:[0,1,1] neg_lo:[1,0,0]
    v_cvt_pk_f16_f32 v82, v180, -v181
    v_cvt_pk_f16_f32 v83, v182, -v183
    v_pk_mul_f32 v[200:201], v[188:189], v[44:45] op_sel:[0,0] op_sel_hi:[1,0]
    v_pk_mul_f32 v[202:203], v[190:191], v[46:47] op_sel:[0,0] op_sel_hi:[1,0]
    v_pk_fma_f32 v[200:201], v[188:189], v[44:45], v[200:201] op_sel:[1,1,0] op_sel_hi:[0,1,1] neg_lo:[1,0,0]
    v_pk_fma_f32 v[202:203], v[190:191], v[46:47], v[202:203] op_sel:[1,1,0] op_sel_hi:[0,1,1] neg_lo:[1,0,0]
    v_cvt_pk_f16_f32 v84, v200, -v201
    v_cvt_pk_f16_f32 v85, v202, -v203
    v_pk_mul_f32 v[204:205], v[196:197], v[44:45] op_sel:[0,0] op_sel_hi:[1,0]
    v_pk_mul_f32 v[206:207], v[198:199], v[46:47] op_sel:[0,0] op_sel_hi:[1,0]
    v_pk_fma_f32 v[204:205], v[196:197], v[44:45], v[204:205] op_sel:[1,1,0] op_sel_hi:[0,1,1] neg_lo:[1,0,0]
    v_pk_fma_f32 v[206:207], v[198:199], v[46:47], v[206:207] op_sel:[1,1,0] op_sel_hi:[0,1,1] neg_lo:[1,0,0]
    v_cvt_pk_f16_f32 v86, v204, -v205
    v_cvt_pk_f16_f32 v87, v206, -v207
    ds_write_b64 v17, v[76:77] offset:8448
    ds_write_b64 v17, v[78:79] offset:8976
    ds_write_b64 v17, v[80:81] offset:9504
    ds_write_b64 v17, v[82:83] offset:10560
    ds_write_b64 v17, v[84:85] offset:11088
    ds_write_b64 v17, v[86:87] offset:11616
    v_pk_mul_f32 v[24:25], v[180:181], v[44:45] op_sel:[0,0] op_sel_hi:[1,0]
    v_pk_mul_f32 v[26:27], v[182:183], v[46:47] op_sel:[0,0] op_sel_hi:[1,0]
    v_pk_fma_f32 v[24:25], v[180:181], v[44:45], v[24:25] op_sel:[1,1,0] op_sel_hi:[0,1,1] neg_lo:[1,0,0]
    v_pk_fma_f32 v[26:27], v[182:183], v[46:47], v[26:27] op_sel:[1,1,0] op_sel_hi:[0,1,1] neg_lo:[1,0,0]
    v_cvt_pk_f16_f32 v88, v24, -v25
    v_cvt_pk_f16_f32 v89, v26, -v27
    v_pk_mul_f32 v[196:197], v[204:205], v[44:45] op_sel:[0,0] op_sel_hi:[1,0]
    v_pk_mul_f32 v[198:199], v[206:207], v[46:47] op_sel:[0,0] op_sel_hi:[1,0]
    v_pk_fma_f32 v[196:197], v[204:205], v[44:45], v[196:197] op_sel:[1,1,0] op_sel_hi:[0,1,1] neg_lo:[1,0,0]
    v_pk_fma_f32 v[198:199], v[206:207], v[46:47], v[198:199] op_sel:[1,1,0] op_sel_hi:[0,1,1] neg_lo:[1,0,0]
    v_cvt_pk_f16_f32 v90, v196, -v197
    v_cvt_pk_f16_f32 v91, v198, -v199
    v_pk_mul_f32 v[180:181], v[24:25], v[44:45] op_sel:[0,0] op_sel_hi:[1,0]
    v_pk_mul_f32 v[182:183], v[26:27], v[46:47] op_sel:[0,0] op_sel_hi:[1,0]
    v_pk_fma_f32 v[180:181], v[24:25], v[44:45], v[180:181] op_sel:[1,1,0] op_sel_hi:[0,1,1] neg_lo:[1,0,0]
    v_pk_fma_f32 v[182:183], v[26:27], v[46:47], v[182:183] op_sel:[1,1,0] op_sel_hi:[0,1,1] neg_lo:[1,0,0]
    v_cvt_pk_f16_f32 v92, v180, -v181
    v_cvt_pk_f16_f32 v93, v182, -v183
    v_pk_mul_f32 v[204:205], v[196:197], v[44:45] op_sel:[0,0] op_sel_hi:[1,0]
    v_pk_mul_f32 v[206:207], v[198:199], v[46:47] op_sel:[0,0] op_sel_hi:[1,0]
    v_pk_fma_f32 v[204:205], v[196:197], v[44:45], v[204:205] op_sel:[1,1,0] op_sel_hi:[0,1,1] neg_lo:[1,0,0]
    v_pk_fma_f32 v[206:207], v[198:199], v[46:47], v[206:207] op_sel:[1,1,0] op_sel_hi:[0,1,1] neg_lo:[1,0,0]
    v_cvt_pk_f16_f32 v94, v204, -v205
    v_cvt_pk_f16_f32 v95, v206, -v207
    ds_write_b64 v17, v[88:89] offset:10032
    ds_write_b64 v17, v[92:93] offset:12144
    ds_write_b64 v17, v[90:91] offset:12672
    ds_write_b64 v17, v[94:95] offset:14784
    v_pk_mul_f32 v[24:25], v[180:181], v[44:45] op_sel:[0,0] op_sel_hi:[1,0]
    v_pk_mul_f32 v[26:27], v[182:183], v[46:47] op_sel:[0,0] op_sel_hi:[1,0]
    v_pk_fma_f32 v[24:25], v[180:181], v[44:45], v[24:25] op_sel:[1,1,0] op_sel_hi:[0,1,1] neg_lo:[1,0,0]
    v_pk_fma_f32 v[26:27], v[182:183], v[46:47], v[26:27] op_sel:[1,1,0] op_sel_hi:[0,1,1] neg_lo:[1,0,0]
    v_cvt_pk_f16_f32 v96, v24, -v25
    v_cvt_pk_f16_f32 v97, v26, -v27
    v_pk_mul_f32 v[196:197], v[204:205], v[44:45] op_sel:[0,0] op_sel_hi:[1,0]
    v_pk_mul_f32 v[198:199], v[206:207], v[46:47] op_sel:[0,0] op_sel_hi:[1,0]
    v_pk_fma_f32 v[196:197], v[204:205], v[44:45], v[196:197] op_sel:[1,1,0] op_sel_hi:[0,1,1] neg_lo:[1,0,0]
    v_pk_fma_f32 v[198:199], v[206:207], v[46:47], v[198:199] op_sel:[1,1,0] op_sel_hi:[0,1,1] neg_lo:[1,0,0]
    v_cvt_pk_f16_f32 v98, v196, -v197
    v_cvt_pk_f16_f32 v99, v198, -v199
    v_pk_mul_f32 v[180:181], v[24:25], v[44:45] op_sel:[0,0] op_sel_hi:[1,0]
    v_pk_mul_f32 v[182:183], v[26:27], v[46:47] op_sel:[0,0] op_sel_hi:[1,0]
    v_pk_fma_f32 v[180:181], v[24:25], v[44:45], v[180:181] op_sel:[1,1,0] op_sel_hi:[0,1,1] neg_lo:[1,0,0]
    v_pk_fma_f32 v[182:183], v[26:27], v[46:47], v[182:183] op_sel:[1,1,0] op_sel_hi:[0,1,1] neg_lo:[1,0,0]
    v_cvt_pk_f16_f32 v100, v180, -v181
    v_cvt_pk_f16_f32 v101, v182, -v183
    v_pk_mul_f32 v[204:205], v[196:197], v[44:45] op_sel:[0,0] op_sel_hi:[1,0]
    v_pk_mul_f32 v[206:207], v[198:199], v[46:47] op_sel:[0,0] op_sel_hi:[1,0]
    v_pk_fma_f32 v[204:205], v[196:197], v[44:45], v[204:205] op_sel:[1,1,0] op_sel_hi:[0,1,1] neg_lo:[1,0,0]
    v_pk_fma_f32 v[206:207], v[198:199], v[46:47], v[206:207] op_sel:[1,1,0] op_sel_hi:[0,1,1] neg_lo:[1,0,0]
    v_cvt_pk_f16_f32 v102, v204, -v205
    v_cvt_pk_f16_f32 v103, v206, -v207
    ds_write_b64 v17, v[96:97] offset:13200
    ds_write_b64 v17, v[98:99] offset:13728
    ds_write_b64 v17, v[100:101] offset:15312
    ds_write_b64 v17, v[102:103] offset:15840
    ds_read_b128 v[48:51], v18 offset:0
    ds_read_b128 v[52:55], v18 offset:32
    ds_read_b128 v[56:59], v18 offset:64
    ds_read_b128 v[60:63], v18 offset:96
    ds_read_b128 v[64:67], v18 offset:128
    ds_read_b128 v[68:71], v18 offset:160
    ds_read_b128 v[72:75], v18 offset:192
    ds_read_b128 v[76:79], v18 offset:224
    ds_read_b128 v[80:83], v18 offset:256
    ds_read_b128 v[84:87], v18 offset:288
    ds_read_b128 v[88:91], v18 offset:320
    ds_read_b128 v[92:95], v18 offset:352
    ds_read_b128 v[96:99], v18 offset:384
    ds_read_b128 v[100:103], v18 offset:416
    ds_read_b128 v[104:107], v18 offset:448
    s_waitcnt lgkmcnt(14)
    v_mfma_f32_32x32x16_f16 v[176:191], v[48:51], v[112:115], 0
    ds_read_b128 v[108:111], v18 offset:480
    s_waitcnt lgkmcnt(14)
    v_mfma_f32_32x32x16_f16 v[176:191], v[52:55], v[116:119], v[176:191]
    s_waitcnt lgkmcnt(13)
    v_mfma_f32_32x32x16_f16 v[176:191], v[56:59], v[120:123], v[176:191]
    s_waitcnt lgkmcnt(12)
    v_mfma_f32_32x32x16_f16 v[176:191], v[60:63], v[124:127], v[176:191]
    s_waitcnt lgkmcnt(11)
    v_mfma_f32_32x32x16_f16 v[176:191], v[64:67], v[128:131], v[176:191]
    s_waitcnt lgkmcnt(10)
    v_mfma_f32_32x32x16_f16 v[176:191], v[68:71], v[132:135], v[176:191]
    s_waitcnt lgkmcnt(9)
    v_mfma_f32_32x32x16_f16 v[176:191], v[72:75], v[136:139], v[176:191]
    s_waitcnt lgkmcnt(8)
    v_mfma_f32_32x32x16_f16 v[176:191], v[76:79], v[140:143], v[176:191]
    s_waitcnt lgkmcnt(7)
    v_mfma_f32_32x32x16_f16 v[176:191], v[80:83], v[144:147], v[176:191]
    s_waitcnt lgkmcnt(6)
    v_mfma_f32_32x32x16_f16 v[176:191], v[84:87], v[148:151], v[176:191]
    s_waitcnt lgkmcnt(5)
    v_mfma_f32_32x32x16_f16 v[176:191], v[88:91], v[152:155], v[176:191]
    s_waitcnt lgkmcnt(4)
    v_mfma_f32_32x32x16_f16 v[176:191], v[92:95], v[156:159], v[176:191]
    s_waitcnt lgkmcnt(3)
    v_mfma_f32_32x32x16_f16 v[176:191], v[96:99], v[160:163], v[176:191]
    s_waitcnt lgkmcnt(2)
    v_mfma_f32_32x32x16_f16 v[176:191], v[100:103], v[164:167], v[176:191]
    s_waitcnt lgkmcnt(1)
    v_mfma_f32_32x32x16_f16 v[176:191], v[104:107], v[168:171], v[176:191]
    s_waitcnt lgkmcnt(0)
    v_mfma_f32_32x32x16_f16 v[176:191], v[108:111], v[172:175], v[176:191]
    s_mov_b32 s90, 0xaaaaaaaa
    s_mov_b32 s91, 0xaaaaaaaa
    s_nop 9
    v_mul_f32 v176, v176, v16
    v_mul_f32 v177, v177, v16
    v_mul_f32 v178, v178, v16
    v_mul_f32 v179, v179, v16
    v_mul_f32 v180, v180, v16
    v_mul_f32 v181, v181, v16
    v_mul_f32 v182, v182, v16
    v_mul_f32 v183, v183, v16
    v_mul_f32 v184, v184, v16
    v_mul_f32 v185, v185, v16
    v_mul_f32 v186, v186, v16
    v_mul_f32 v187, v187, v16
    v_mul_f32 v188, v188, v16
    v_mul_f32 v189, v189, v16
    v_mul_f32 v190, v190, v16
    v_mul_f32 v191, v191, v16
    v_mov_b32 v112, 0
    v_mov_b32 v113, 0
    v_mov_b32 v114, 0
    v_mov_b32 v115, 0
    v_mov_b32 v116, 0
    v_mov_b32 v117, 0
    v_mov_b32 v118, 0
    v_mov_b32 v119, 0
    v_mov_b32 v120, 0
    v_mov_b32 v121, 0
    v_mov_b32 v122, 0
    v_mov_b32 v123, 0
    v_mov_b32 v7, v191
    v_mov_b32 v8, v191
    v_cndmask_b32 v5, v187, v188, s[90:91]
    v_cndmask_b32 v6, v189, v190, s[90:91]
    v_mov_b32_dpp v7, v177 wave_shl:1 row_mask:0xf bank_mask:0xf
    v_mov_b32_dpp v8, v178 wave_shl:1 row_mask:0xf bank_mask:0xf
    s_setprio 0
    s_mul_i32 s72, s68, 16896
    s_add_u32 s72, s72, 78848
    s_add_u32 s73, s72, 1008
    v_sub_u32 v17, s73, v4
    v_add_u32 v18, s72, v4
    v_cvt_pk_bf16_f32 v52, v186, v186
    v_cvt_pk_bf16_f32 v53, v185, v185
    v_cvt_pk_bf16_f32 v54, v185, v184
    v_cvt_pk_bf16_f32 v55, v184, v184
    v_cvt_pk_bf16_f32 v68, v186, v186
    v_cvt_pk_bf16_f32 v69, v186, v185
    v_cvt_pk_bf16_f32 v70, v185, v185
    v_cvt_pk_bf16_f32 v71, v184, v184
    v_cvt_pk_bf16_f32 v84, v186, v186
    v_cvt_pk_bf16_f32 v85, v186, v186
    v_cvt_pk_bf16_f32 v86, v185, v185
    v_cvt_pk_bf16_f32 v87, v185, v184
    v_cvt_pk_bf16_f32 v100, v186, v186
    v_cvt_pk_bf16_f32 v101, v186, v186
    v_cvt_pk_bf16_f32 v102, v186, v185
    v_cvt_pk_bf16_f32 v103, v185, v185
    ds_write_b128 v17, v[68:71] offset:2048
    ds_write_b128 v17, v[84:87] offset:6208
    ds_write_b128 v17, v[100:103] offset:10368
    ds_write_b64 v17, v[52:53] offset:14536
    ds_write_b64 v17, v[54:55] offset:14544
    v_cvt_pk_bf16_f32 v56, v188, v188
    v_cvt_pk_bf16_f32 v57, v188, v5
    v_cvt_pk_bf16_f32 v58, v187, v187
    v_cvt_pk_bf16_f32 v59, v187, v187
    v_cvt_pk_bf16_f32 v72, v188, v188
    v_cvt_pk_bf16_f32 v73, v188, v188
    v_cvt_pk_bf16_f32 v74, v5, v187
    v_cvt_pk_bf16_f32 v75, v187, v187
    v_cvt_pk_bf16_f32 v88, v188, v188
    v_cvt_pk_bf16_f32 v89, v188, v188
    v_cvt_pk_bf16_f32 v90, v188, v5
    v_cvt_pk_bf16_f32 v91, v187, v187
    v_cvt_pk_bf16_f32 v104, v188, v188
    v_cvt_pk_bf16_f32 v105, v188, v188
    v_cvt_pk_bf16_f32 v106, v188, v188
    v_cvt_pk_bf16_f32 v107, v5, v187
    ds_write_b128 v17, v[72:75] offset:1024
    ds_write_b128 v17, v[88:91] offset:5184
    ds_write_b128 v17, v[104:107] offset:9344
    ds_write_b64 v17, v[56:57] offset:13512
    ds_write_b64 v17, v[58:59] offset:13520
    v_cvt_pk_bf16_f32 v60, v190, v190
    v_cvt_pk_bf16_f32 v61, v190, v6
    v_cvt_pk_bf16_f32 v62, v189, v189
    v_cvt_pk_bf16_f32 v63, v189, v189
    v_cvt_pk_bf16_f32 v76, v190, v190
    v_cvt_pk_bf16_f32 v77, v190, v190
    v_cvt_pk_bf16_f32 v78, v6, v189
    v_cvt_pk_bf16_f32 v79, v189, v189
    v_cvt_pk_bf16_f32 v92, v190, v190
    v_cvt_pk_bf16_f32 v93, v190, v190
    v_cvt_pk_bf16_f32 v94, v190, v6
    v_cvt_pk_bf16_f32 v95, v189, v189
    v_cvt_pk_bf16_f32 v108, v190, v190
    v_cvt_pk_bf16_f32 v109, v190, v190
    v_cvt_pk_bf16_f32 v110, v190, v190
    v_cvt_pk_bf16_f32 v111, v6, v189
    ds_write_b128 v17, v[76:79] offset:0
    ds_write_b128 v17, v[92:95] offset:4160
    ds_write_b128 v17, v[108:111] offset:8320
    ds_write_b64 v17, v[60:61] offset:12488
    ds_write_b64 v17, v[62:63] offset:12496
    v_cvt_pk_bf16_f32 v48, v183, v182
    v_cvt_pk_bf16_f32 v49, v181, v180
    v_cvt_pk_bf16_f32 v50, v179, v178
    v_cvt_pk_bf16_f32 v51, v177, v176
    v_cvt_pk_bf16_f32 v64, v191, v183
    v_cvt_pk_bf16_f32 v65, v182, v181
    v_cvt_pk_bf16_f32 v66, v180, v179
    v_cvt_pk_bf16_f32 v67, v178, v177
    v_cvt_pk_bf16_f32 v80, v7, v191
    v_cvt_pk_bf16_f32 v81, v183, v182
    v_cvt_pk_bf16_f32 v82, v181, v180
    v_cvt_pk_bf16_f32 v83, v179, v178
    v_cvt_pk_bf16_f32 v96, v8, v7
    v_cvt_pk_bf16_f32 v97, v191, v183
    v_cvt_pk_bf16_f32 v98, v182, v181
    v_cvt_pk_bf16_f32 v99, v180, v179
    ds_write_b128 v17, v[64:67] offset:3072
    ds_write_b128 v17, v[80:83] offset:7232
    ds_write_b128 v17, v[96:99] offset:11392
    ds_write_b64 v17, v[48:49] offset:15560
    ds_write_b64 v17, v[50:51] offset:15568
    s_mov_b64 exec, 1
    v_cvt_pk_bf16_f32 v112, v176, 0
    v_cvt_pk_bf16_f32 v116, v177, v176
    v_cvt_pk_bf16_f32 v120, v178, v177
    v_cvt_pk_bf16_f32 v121, v176, 0
    s_mov_b64 exec, 15
    ds_write_b128 v18, v[112:115] offset:4096
    ds_write_b128 v18, v[116:119] offset:8256
    ds_write_b128 v18, v[120:123] offset:12416
    ds_write_b64 v18, v[114:115] offset:16584
    ds_write_b64 v18, v[114:115] offset:16592
    s_mov_b64 exec, -1
    s_lshl_b32 s72, s68, 2
    s_add_u32 s72, s72, 153888
    v_mov_b32 v7, s72
    v_mov_b32 v8, 10
    ds_write_b32 v7, v8
    v_cmp_eq_u32 vcc, 20, v2
    v_mov_b32 v6, 0x3f803f80
    v_mov_b32 v128, v6
    v_mov_b32 v129, v6
    v_mov_b32 v130, v6
    v_mov_b32 v131, v6
    v_mov_b32 v132, v6
    v_mov_b32 v133, v6
    v_mov_b32 v134, v6
    v_mov_b32 v135, v6
    v_mov_b32 v136, v6
    v_mov_b32 v137, v6
    v_mov_b32 v138, v6
    v_mov_b32 v139, v6
    v_mov_b32 v140, v6
    v_mov_b32 v141, v6
    v_mov_b32 v142, v6
    v_mov_b32 v143, v6
    v_cndmask_b32 v5, 0, v6, vcc
    v_mov_b32 v144, v5
    v_mov_b32 v145, v5
    v_mov_b32 v146, v5
    v_mov_b32 v147, v5
    v_mov_b32 v148, v5
    v_mov_b32 v149, v5
    v_mov_b32 v150, v5
    v_mov_b32 v151, v5
    v_mov_b32 v152, v5
    v_mov_b32 v153, v5
    v_mov_b32 v154, v5
    v_mov_b32 v155, v5
    v_mov_b32 v156, v5
    v_mov_b32 v157, v5
    v_mov_b32 v158, v5
    v_mov_b32 v159, v5
    v_mov_b32 v160, v5
    v_mov_b32 v161, v5
    v_mov_b32 v162, v5
    v_mov_b32 v163, v5
    v_mov_b32 v164, v5
    v_mov_b32 v165, v5
    v_mov_b32 v166, v5
    v_mov_b32 v167, v5
    v_mov_b32 v168, v5
    v_mov_b32 v169, v5
    v_mov_b32 v170, v5
    v_mov_b32 v171, v5
    v_mov_b32 v172, v5
    v_mov_b32 v173, v5
    v_mov_b32 v174, v5
    v_mov_b32 v175, v5
    v_mov_b32 v176, v5
    v_mov_b32 v177, v5
    v_mov_b32 v178, v5
    v_mov_b32 v179, v5
    v_mov_b32 v180, v5
    v_mov_b32 v181, v5
    v_mov_b32 v182, v5
    v_mov_b32 v183, v5
    v_mov_b32 v184, v5
    v_mov_b32 v185, v5
    v_mov_b32 v186, v5
    v_mov_b32 v187, v5
    v_mov_b32 v188, v5
    v_mov_b32 v189, v5
    v_mov_b32 v190, v5
    v_mov_b32 v191, v5
    v_mov_b32 v192, v5
    v_mov_b32 v193, v5
    v_mov_b32 v194, v5
    v_mov_b32 v195, v5
    v_mov_b32 v196, v5
    v_mov_b32 v197, v5
    v_mov_b32 v198, v5
    v_mov_b32 v199, v5
    v_mov_b32 v200, v5
    v_mov_b32 v201, v5
    v_mov_b32 v202, v5
    v_mov_b32 v203, v5
    v_mov_b32 v204, v5
    v_mov_b32 v205, v5
    v_mov_b32 v206, v5
    v_mov_b32 v207, v5
    s_waitcnt lgkmcnt(0)
    s_mul_i32 s71, s71, 0x9e3779b1
    s_add_u32 s71, s71, 0x7f4a7c15
    s_setprio 0
    s_branch L_join
L_load:
    s_setprio 3
    v_lshrrev_b32 v5, 3, v1
    v_mul_u32_u24 v5, 1280, v5
    v_lshrrev_b32 v6, 4, v1
    v_xor_b32 v6, v6, v1
    v_and_b32 v6, 7, v6
    v_lshl_add_u32 v12, v6, 4, v5
    v_xor_b32 v13, 64, v12
    s_mul_i32 s77, s69, 81920
    s_mul_i32 s78, s70, 160
    s_mov_b32 s76, s70
    s_lshl_b32 s72, s76, 7
    s_add_u32 s72, s72, s77
    s_mov_b32 m0, 0
    s_add_u32 s73, s72, 0
    buffer_load_dwordx4 v12, s[12:15], s73 offen lds
    s_mov_b32 m0, 1024
    s_add_u32 s73, s72, 10240
    buffer_load_dwordx4 v13, s[12:15], s73 offen lds
    s_mov_b32 m0, 2048
    s_add_u32 s73, s72, 20480
    buffer_load_dwordx4 v12, s[12:15], s73 offen lds
    s_mov_b32 m0, 3072
    s_add_u32 s73, s72, 30720
    buffer_load_dwordx4 v13, s[12:15], s73 offen lds
    s_mov_b32 m0, 4096
    s_add_u32 s73, s72, 40960
    buffer_load_dwordx4 v12, s[12:15], s73 offen lds
    s_mov_b32 m0, 5120
    s_add_u32 s73, s72, 51200
    buffer_load_dwordx4 v13, s[12:15], s73 offen lds
    s_mov_b32 m0, 6144
    s_add_u32 s73, s72, 61440
    buffer_load_dwordx4 v12, s[12:15], s73 offen lds
    s_mov_b32 m0, 7168
    s_add_u32 s73, s72, 71680
    buffer_load_dwordx4 v13, s[12:15], s73 offen lds
    s_mov_b32 s16, s52
    s_and_b32 s17, s53, 0xffff
    s_mov_b32 s18, 0xc8000
    s_mov_b32 s19, 0x00020000
    v_add_u32 v5, 0, v1
    v_mul_u32_u24 v6, 6554, v5
    v_lshrrev_b32 v6, 16, v6
    v_mul_u32_u24 v22, 10, v6
    v_sub_u32 v5, v5, v22
    v_bfe_u32 v22, v6, 1, 2
    v_and_b32 v23, 1, v6
    v_lshl_add_u32 v22, v23, 2, v22
    v_and_b32 v6, 0xf8, v6
    v_add_u32 v6, v6, v22
    v_mul_u32_u24 v6, 1280, v6
    v_lshl_add_u32 v14, v5, 4, v6
    v_add_u32 v5, 64, v1
    v_mul_u32_u24 v6, 6554, v5
    v_lshrrev_b32 v6, 16, v6
    v_mul_u32_u24 v22, 10, v6
    v_sub_u32 v5, v5, v22
    v_bfe_u32 v22, v6, 1, 2
    v_and_b32 v23, 1, v6
    v_lshl_add_u32 v22, v23, 2, v22
    v_and_b32 v6, 0xf8, v6
    v_add_u32 v6, v6, v22
    v_mul_u32_u24 v6, 1280, v6
    v_lshl_add_u32 v15, v5, 4, v6
    v_add_u32 v5, 128, v1
    v_mul_u32_u24 v6, 6554, v5
    v_lshrrev_b32 v6, 16, v6
    v_mul_u32_u24 v22, 10, v6
    v_sub_u32 v5, v5, v22
    v_bfe_u32 v22, v6, 1, 2
    v_and_b32 v23, 1, v6
    v_lshl_add_u32 v22, v23, 2, v22
    v_and_b32 v6, 0xf8, v6
    v_add_u32 v6, v6, v22
    v_mul_u32_u24 v6, 1280, v6
    v_lshl_add_u32 v16, v5, 4, v6
    v_add_u32 v5, 192, v1
    v_mul_u32_u24 v6, 6554, v5
    v_lshrrev_b32 v6, 16, v6
    v_mul_u32_u24 v22, 10, v6
    v_sub_u32 v5, v5, v22
    v_bfe_u32 v22, v6, 1, 2
    v_and_b32 v23, 1, v6
    v_lshl_add_u32 v22, v23, 2, v22
    v_and_b32 v6, 0xf8, v6
    v_add_u32 v6, v6, v22
    v_mul_u32_u24 v6, 1280, v6
    v_lshl_add_u32 v17, v5, 4, v6
    v_add_u32 v5, 256, v1
    v_mul_u32_u24 v6, 6554, v5
    v_lshrrev_b32 v6, 16, v6
    v_mul_u32_u24 v22, 10, v6
    v_sub_u32 v5, v5, v22
    v_bfe_u32 v22, v6, 1, 2
    v_and_b32 v23, 1, v6
    v_lshl_add_u32 v22, v23, 2, v22
    v_and_b32 v6, 0xf8, v6
    v_add_u32 v6, v6, v22
    v_mul_u32_u24 v6, 1280, v6
    v_lshl_add_u32 v18, v5, 4, v6
    s_mov_b32 s20, s54
    s_and_b32 s21, s55, 0xffff
    s_mov_b32 s22, 0x6400
    s_mov_b32 s23, 0x00020000
    s_and_b32 s72, s57, 0xffff
    s_cmp_ge_u32 s70, 3
    s_cselect_b32 s20, s56, s20
    s_cselect_b32 s21, s72, s21
    s_cselect_b32 s72, 3, 0
    s_sub_u32 s72, s70, s72
    s_lshl_b32 s79, s72, 4
    s_min_u32 s79, s79, 24
    v_mul_u32_u24 v19, 40, v1
    s_mov_b32 s82, 2560
    s_cmp_lt_u32 s70, 6
    s_cbranch_scc1 L_ldk
    s_mov_b32 s20, s60
    s_and_b32 s21, s61, 0xffff
    s_mov_b32 s22, 0x504
    s_mov_b32 s23, 0x00020000
    s_cmp_eq_u32 s70, 7
    s_cselect_b32 s22, 0, s22
    s_mov_b32 s79, 0
    s_mov_b32 s82, 128
    v_lshlrev_b32 v19, 1, v1
L_ldk:
    v_mov_b32 v20, 153856
    s_mul_i32 s72, s76, 81920
    s_add_u32 s72, s72, s78
    s_add_u32 s73, s72, 40960
    s_mov_b32 m0, 8192
    s_nop 0
    buffer_load_dwordx4 v14, s[16:19], s72 offen lds
    s_mov_b32 m0, 9216
    s_nop 0
    buffer_load_dwordx4 v15, s[16:19], s72 offen lds
    s_mov_b32 m0, 10240
    s_nop 0
    buffer_load_dwordx4 v16, s[16:19], s72 offen lds
    s_mov_b32 m0, 11264
    s_nop 0
    buffer_load_dwordx4 v17, s[16:19], s72 offen lds
    s_mov_b32 m0, 12288
    s_nop 0
    buffer_load_dwordx4 v18, s[16:19], s72 offen lds
    s_mov_b32 m0, 13312
    s_nop 0
    buffer_load_dwordx4 v14, s[16:19], s73 offen lds
    s_mov_b32 m0, 14336
    s_nop 0
    buffer_load_dwordx4 v15, s[16:19], s73 offen lds
    s_mov_b32 m0, 15360
    s_nop 0
    buffer_load_dwordx4 v16, s[16:19], s73 offen lds
    s_mov_b32 m0, 16384
    s_nop 0
    buffer_load_dwordx4 v17, s[16:19], s73 offen lds
    s_mov_b32 m0, 17408
    s_nop 0
    buffer_load_dwordx4 v18, s[16:19], s73 offen lds
    s_mul_i32 s72, s76, s82
    s_mov_b32 m0, 18432
    s_add_u32 s72, s72, s79
    buffer_load_dwordx4 v19, s[20:23], s72 offen lds
    s_mov_b32 s76, s86
    s_mov_b32 s75, 3000000
    s_lshl_b32 s72, s76, 7
    s_add_u32 s72, s72, s77
    s_mov_b32 m0, 19712
    s_add_u32 s73, s72, 0
    buffer_load_dwordx4 v12, s[12:15], s73 offen lds
    s_mov_b32 m0, 20736
    s_add_u32 s73, s72, 10240
    buffer_load_dwordx4 v13, s[12:15], s73 offen lds
    s_mov_b32 m0, 21760
    s_add_u32 s73, s72, 20480
    buffer_load_dwordx4 v12, s[12:15], s73 offen lds
    s_mov_b32 m0, 22784
    s_add_u32 s73, s72, 30720
    buffer_load_dwordx4 v13, s[12:15], s73 offen lds
    s_mov_b32 m0, 23808
    s_add_u32 s73, s72, 40960
    buffer_load_dwordx4 v12, s[12:15], s73 offen lds
    s_mov_b32 m0, 24832
    s_add_u32 s73, s72, 51200
    buffer_load_dwordx4 v13, s[12:15], s73 offen lds
    s_mov_b32 m0, 25856
    s_add_u32 s73, s72, 61440
    buffer_load_dwordx4 v12, s[12:15], s73 offen lds
    s_mov_b32 m0, 26880
    s_add_u32 s73, s72, 71680
    buffer_load_dwordx4 v13, s[12:15], s73 offen lds
    s_mul_i32 s72, s76, 81920
    s_add_u32 s72, s72, s78
    s_add_u32 s73, s72, 40960
    s_mov_b32 m0, 27904
    s_nop 0
    buffer_load_dwordx4 v14, s[16:19], s72 offen lds
    s_mov_b32 m0, 28928
    s_nop 0
    buffer_load_dwordx4 v15, s[16:19], s72 offen lds
    s_mov_b32 m0, 29952
    s_nop 0
    buffer_load_dwordx4 v16, s[16:19], s72 offen lds
    s_mov_b32 m0, 30976
    s_nop 0
    buffer_load_dwordx4 v17, s[16:19], s72 offen lds
    s_mov_b32 m0, 32000
    s_nop 0
    buffer_load_dwordx4 v18, s[16:19], s72 offen lds
    s_mov_b32 m0, 33024
    s_nop 0
    buffer_load_dwordx4 v14, s[16:19], s73 offen lds
    s_mov_b32 m0, 34048
    s_nop 0
    buffer_load_dwordx4 v15, s[16:19], s73 offen lds
    s_mov_b32 m0, 35072
    s_nop 0
    buffer_load_dwordx4 v16, s[16:19], s73 offen lds
    s_mov_b32 m0, 36096
    s_nop 0
    buffer_load_dwordx4 v17, s[16:19], s73 offen lds
    s_mov_b32 m0, 37120
    s_nop 0
    buffer_load_dwordx4 v18, s[16:19], s73 offen lds
    s_mul_i32 s72, s76, s82
    s_mov_b32 m0, 38144
    s_add_u32 s72, s72, s79
    buffer_load_dwordx4 v19, s[20:23], s72 offen lds
    s_add_u32 s76, s76, 1
    s_cmp_eq_u32 s76, 10
    s_cselect_b32 s76, 0, s76
    s_cmp_eq_u32 s76, s70
    s_addc_u32 s76, s76, 0
    s_waitcnt lgkmcnt(0)
    s_mul_i32 s71, s71, 0x9e3779b1
    s_add_u32 s71, s71, 0x7f4a7c15
    s_add_u32 s72, s6, 0
    s_lshr_b32 s72, s72, 4
    s_lshl_b32 s72, s72, 12
    v_lshl_add_u32 v28, v2, 7, s72
    s_add_u32 s72, s6, 2
    s_lshr_b32 s72, s72, 4
    s_lshl_b32 s72, s72, 12
    s_mov_b64 exec, s[88:89]
    v_lshl_add_u32 v28, v2, 7, s72
    s_mov_b64 exec, -1
    v_add_u32 v5, 0, v1
    v_mul_u32_u24 v6, 13108, v5
    v_lshrrev_b32 v6, 16, v6
    v_sub_u32 v5, v5, v6
    v_lshlrev_b32 v5, 4, v5
    v_subrev_u32 v30, 1984, v5
    v_add_u32 v5, 64, v1
    v_mul_u32_u24 v6, 13108, v5
    v_lshrrev_b32 v6, 16, v6
    v_sub_u32 v5, v5, v6
    v_lshlrev_b32 v5, 4, v5
    v_subrev_u32 v31, 1984, v5
    v_add_u32 v5, 128, v1
    v_mul_u32_u24 v6, 13108, v5
    v_lshrrev_b32 v6, 16, v6
    v_sub_u32 v5, v5, v6
    v_lshlrev_b32 v5, 4, v5
    v_subrev_u32 v32, 1984, v5
    v_add_u32 v5, 192, v1
    v_mul_u32_u24 v6, 13108, v5
    v_lshrrev_b32 v6, 16, v6
    v_sub_u32 v5, v5, v6
    v_lshlrev_b32 v5, 4, v5
    v_subrev_u32 v33, 1984, v5
    v_add_u32 v5, 256, v1
    v_mul_u32_u24 v6, 13108, v5
    v_lshrrev_b32 v6, 16, v6
    v_sub_u32 v5, v5, v6
    v_lshlrev_b32 v5, 4, v5
    v_subrev_u32 v34, 1984, v5
    v_add_u32 v5, 320, v1
    v_mul_u32_u24 v6, 13108, v5
    v_lshrrev_b32 v6, 16, v6
    v_sub_u32 v5, v5, v6
    v_lshlrev_b32 v5, 4, v5
    v_subrev_u32 v35, 1984, v5
    v_add_u32 v5, 384, v1
    v_mul_u32_u24 v6, 13108, v5
    v_lshrrev_b32 v6, 16, v6
    v_sub_u32 v5, v5, v6
    v_lshlrev_b32 v5, 4, v5
    v_subrev_u32 v36, 1984, v5
    v_add_u32 v5, 448, v1
    v_mul_u32_u24 v6, 13108, v5
    v_lshrrev_b32 v6, 16, v6
    v_sub_u32 v5, v5, v6
    v_lshlrev_b32 v5, 4, v5
    v_subrev_u32 v37, 1984, v5
    s_mov_b32 s80, 0x780000
    s_mov_b32 m0, 129536
    s_nop 0
    buffer_load_dwordx4 v30, s[8:11], s80 offen lds
    s_mov_b32 m0, 130560
    s_nop 0
    buffer_load_dwordx4 v31, s[8:11], s80 offen lds
    s_mov_b32 m0, 137216
    s_nop 0
    buffer_load_dwordx4 v30, s[8:11], s80 offen lds
    s_mov_b32 m0, 138240
    s_nop 0
    buffer_load_dwordx4 v31, s[8:11], s80 offen lds
    s_mov_b32 m0, 144896
    s_nop 0
    buffer_load_dwordx4 v30, s[8:11], s80 offen lds
    s_mov_b32 m0, 145920
    s_nop 0
    buffer_load_dwordx4 v31, s[8:11], s80 offen lds
    s_lshl_b32 s72, s76, 7
    s_add_u32 s72, s72, s77
    s_mov_b32 m0, 39424
    s_add_u32 s73, s72, 0
    buffer_load_dwordx4 v12, s[12:15], s73 offen lds
    s_mov_b32 m0, 40448
    s_add_u32 s73, s72, 10240
    buffer_load_dwordx4 v13, s[12:15], s73 offen lds
    s_mov_b32 m0, 41472
    s_add_u32 s73, s72, 20480
    buffer_load_dwordx4 v12, s[12:15], s73 offen lds
    s_mov_b32 m0, 42496
    s_add_u32 s73, s72, 30720
    buffer_load_dwordx4 v13, s[12:15], s73 offen lds
    s_mov_b32 m0, 43520
    s_add_u32 s73, s72, 40960
    buffer_load_dwordx4 v12, s[12:15], s73 offen lds
    s_mov_b32 m0, 44544
    s_add_u32 s73, s72, 51200
    buffer_load_dwordx4 v13, s[12:15], s73 offen lds
    s_mov_b32 m0, 45568
    s_add_u32 s73, s72, 61440
    buffer_load_dwordx4 v12, s[12:15], s73 offen lds
    s_mov_b32 m0, 46592
    s_add_u32 s73, s72, 71680
    buffer_load_dwordx4 v13, s[12:15], s73 offen lds
    v_mov_b32 v21, 1
    s_waitcnt vmcnt(33)
    ds_write_b32 v20, v21
    s_mul_i32 s72, s76, 81920
    s_add_u32 s72, s72, s78
    s_add_u32 s73, s72, 40960
    s_mov_b32 m0, 47616
    s_nop 0
    buffer_load_dwordx4 v14, s[16:19], s72 offen lds
    s_mov_b32 m0, 48640
    s_nop 0
    buffer_load_dwordx4 v15, s[16:19], s72 offen lds
    s_mov_b32 m0, 49664
    s_nop 0
    buffer_load_dwordx4 v16, s[16:19], s72 offen lds
    s_mov_b32 m0, 50688
    s_nop 0
    buffer_load_dwordx4 v17, s[16:19], s72 offen lds
    s_mov_b32 m0, 51712
    s_nop 0
    buffer_load_dwordx4 v18, s[16:19], s72 offen lds
    s_mov_b32 m0, 52736
    s_nop 0
    buffer_load_dwordx4 v14, s[16:19], s73 offen lds
    s_mov_b32 m0, 53760
    s_nop 0
    buffer_load_dwordx4 v15, s[16:19], s73 offen lds
    s_mov_b32 m0, 54784
    s_nop 0
    buffer_load_dwordx4 v16, s[16:19], s73 offen lds
    s_mov_b32 m0, 55808
    s_nop 0
    buffer_load_dwordx4 v17, s[16:19], s73 offen lds
    s_mov_b32 m0, 56832
    s_nop 0
    buffer_load_dwordx4 v18, s[16:19], s73 offen lds
    s_mul_i32 s72, s76, s82
    s_mov_b32 m0, 57856
    s_add_u32 s72, s72, s79
    buffer_load_dwordx4 v19, s[20:23], s72 offen lds
    s_add_u32 s76, s76, 1
    s_cmp_eq_u32 s76, 10
    s_cselect_b32 s76, 0, s76
    s_cmp_eq_u32 s76, s70
    s_addc_u32 s76, s76, 0
    s_lshl_b32 s72, s76, 7
    s_add_u32 s72, s72, s77
    s_mov_b32 m0, 59136
    s_add_u32 s73, s72, 0
    buffer_load_dwordx4 v12, s[12:15], s73 offen lds
    s_mov_b32 m0, 60160
    s_add_u32 s73, s72, 10240
    buffer_load_dwordx4 v13, s[12:15], s73 offen lds
    s_mov_b32 m0, 61184
    s_add_u32 s73, s72, 20480
    buffer_load_dwordx4 v12, s[12:15], s73 offen lds
    s_mov_b32 m0, 62208
    s_add_u32 s73, s72, 30720
    buffer_load_dwordx4 v13, s[12:15], s73 offen lds
    s_mov_b32 m0, 63232
    s_add_u32 s73, s72, 40960
    buffer_load_dwordx4 v12, s[12:15], s73 offen lds
    s_mov_b32 m0, 64256
    s_add_u32 s73, s72, 51200
    buffer_load_dwordx4 v13, s[12:15], s73 offen lds
    s_mov_b32 m0, 65280
    s_add_u32 s73, s72, 61440
    buffer_load_dwordx4 v12, s[12:15], s73 offen lds
    s_mov_b32 m0, 66304
    s_add_u32 s73, s72, 71680
    buffer_load_dwordx4 v13, s[12:15], s73 offen lds
    v_mov_b32 v21, 2
    s_waitcnt vmcnt(33)
    ds_write_b32 v20, v21
    s_mul_i32 s72, s76, 81920
    s_add_u32 s72, s72, s78
    s_add_u32 s73, s72, 40960
    s_mov_b32 m0, 67328
    s_nop 0
    buffer_load_dwordx4 v14, s[16:19], s72 offen lds
    s_mov_b32 m0, 68352
    s_nop 0
    buffer_load_dwordx4 v15, s[16:19], s72 offen lds
    s_mov_b32 m0, 69376
    s_nop 0
    buffer_load_dwordx4 v16, s[16:19], s72 offen lds
    s_mov_b32 m0, 70400
    s_nop 0
    buffer_load_dwordx4 v17, s[16:19], s72 offen lds
    s_mov_b32 m0, 71424
    s_nop 0
    buffer_load_dwordx4 v18, s[16:19], s72 offen lds
    s_mov_b32 m0, 72448
    s_nop 0
    buffer_load_dwordx4 v14, s[16:19], s73 offen lds
    s_mov_b32 m0, 73472
    ds_read_b128 v[24:27], v20 offset:16
    buffer_load_dwordx4 v15, s[16:19], s73 offen lds
    s_mov_b32 m0, 74496
    s_nop 0
    buffer_load_dwordx4 v16, s[16:19], s73 offen lds
    s_mov_b32 m0, 75520
    s_nop 0
    buffer_load_dwordx4 v17, s[16:19], s73 offen lds
    s_mov_b32 m0, 76544
    s_nop 0
    buffer_load_dwordx4 v18, s[16:19], s73 offen lds
    s_mul_i32 s72, s76, s82
    s_mov_b32 m0, 77568
    s_add_u32 s72, s72, s79
    buffer_load_dwordx4 v19, s[20:23], s72 offen lds
    s_add_u32 s76, s76, 1
    s_cmp_eq_u32 s76, 10
    s_cselect_b32 s76, 0, s76
    s_cmp_eq_u32 s76, s70
    s_addc_u32 s76, s76, 0
L_sf0:
    s_waitcnt lgkmcnt(0)
    v_min_u32 v24, v24, v25
    v_min3_u32 v24, v24, v26, v27
    s_nop 0
    v_readfirstlane_b32 s74, v24
    s_nop 0
    s_cmp_le_u32 s74, 0
    s_cbranch_scc1 L_sfr0
    s_lshl_b32 s72, s76, 7
    s_add_u32 s72, s72, s77
    s_mov_b32 m0, 0
    s_add_u32 s73, s72, 0
    buffer_load_dwordx4 v12, s[12:15], s73 offen lds
    s_mov_b32 m0, 1024
    s_add_u32 s73, s72, 10240
    buffer_load_dwordx4 v13, s[12:15], s73 offen lds
    s_mov_b32 m0, 2048
    s_add_u32 s73, s72, 20480
    buffer_load_dwordx4 v12, s[12:15], s73 offen lds
    s_mov_b32 m0, 3072
    s_add_u32 s73, s72, 30720
    buffer_load_dwordx4 v13, s[12:15], s73 offen lds
    s_mov_b32 m0, 4096
    s_add_u32 s73, s72, 40960
    buffer_load_dwordx4 v12, s[12:15], s73 offen lds
    s_mov_b32 m0, 5120
    s_add_u32 s73, s72, 51200
    buffer_load_dwordx4 v13, s[12:15], s73 offen lds
    s_mov_b32 m0, 6144
    s_add_u32 s73, s72, 61440
    buffer_load_dwordx4 v12, s[12:15], s73 offen lds
    s_mov_b32 m0, 7168
    s_add_u32 s73, s72, 71680
    buffer_load_dwordx4 v13, s[12:15], s73 offen lds
    v_mov_b32 v21, 3
    s_waitcnt vmcnt(27)
    ds_write_b32 v20, v21
    s_mul_i32 s72, s76, 81920
    s_add_u32 s72, s72, s78
    s_add_u32 s73, s72, 40960
    s_mov_b32 m0, 8192
    s_nop 0
    buffer_load_dwordx4 v14, s[16:19], s72 offen lds
    s_mov_b32 m0, 9216
    s_nop 0
    buffer_load_dwordx4 v15, s[16:19], s72 offen lds
    s_mov_b32 m0, 10240
    s_nop 0
    buffer_load_dwordx4 v16, s[16:19], s72 offen lds
    s_mov_b32 m0, 11264
    s_nop 0
    buffer_load_dwordx4 v17, s[16:19], s72 offen lds
    s_mov_b32 m0, 12288
    s_nop 0
    buffer_load_dwordx4 v18, s[16:19], s72 offen lds
    s_mov_b32 m0, 13312
    s_nop 0
    buffer_load_dwordx4 v14, s[16:19], s73 offen lds
    s_mov_b32 m0, 14336
    ds_read_b128 v[24:27], v20 offset:16
    buffer_load_dwordx4 v15, s[16:19], s73 offen lds
    s_mov_b32 m0, 15360
    s_nop 0
    buffer_load_dwordx4 v16, s[16:19], s73 offen lds
    s_mov_b32 m0, 16384
    s_nop 0
    buffer_load_dwordx4 v17, s[16:19], s73 offen lds
    s_mov_b32 m0, 17408
    s_nop 0
    buffer_load_dwordx4 v18, s[16:19], s73 offen lds
    s_mul_i32 s72, s76, s82
    s_mov_b32 m0, 18432
    s_add_u32 s72, s72, s79
    buffer_load_dwordx4 v19, s[20:23], s72 offen lds
    s_add_u32 s76, s76, 1
    s_cmp_eq_u32 s76, 10
    s_cselect_b32 s76, 0, s76
    s_cmp_eq_u32 s76, s70
    s_addc_u32 s76, s76, 0
L_sf1:
    s_waitcnt lgkmcnt(0)
    v_min_u32 v24, v24, v25
    v_min3_u32 v24, v24, v26, v27
    s_nop 0
    v_readfirstlane_b32 s74, v24
    s_nop 0
    s_cmp_le_u32 s74, 1
    s_cbranch_scc1 L_sfr1
    s_lshl_b32 s72, s76, 7
    s_add_u32 s72, s72, s77
    s_mov_b32 m0, 19712
    s_add_u32 s73, s72, 0
    buffer_load_dwordx4 v12, s[12:15], s73 offen lds
    s_mov_b32 m0, 20736
    s_add_u32 s73, s72, 10240
    buffer_load_dwordx4 v13, s[12:15], s73 offen lds
    s_mov_b32 m0, 21760
    s_add_u32 s73, s72, 20480
    buffer_load_dwordx4 v12, s[12:15], s73 offen lds
    s_mov_b32 m0, 22784
    s_add_u32 s73, s72, 30720
    buffer_load_dwordx4 v13, s[12:15], s73 offen lds
    s_mov_b32 m0, 23808
    s_add_u32 s73, s72, 40960
    buffer_load_dwordx4 v12, s[12:15], s73 offen lds
    s_mov_b32 m0, 24832
    s_add_u32 s73, s72, 51200
    buffer_load_dwordx4 v13, s[12:15], s73 offen lds
    s_mov_b32 m0, 25856
    s_add_u32 s73, s72, 61440
    buffer_load_dwordx4 v12, s[12:15], s73 offen lds
    s_mov_b32 m0, 26880
    s_add_u32 s73, s72, 71680
    buffer_load_dwordx4 v13, s[12:15], s73 offen lds
    v_mov_b32 v21, 4
    s_waitcnt vmcnt(27)
    ds_write_b32 v20, v21
    s_mul_i32 s72, s76, 81920
    s_add_u32 s72, s72, s78
    s_add_u32 s73, s72, 40960
    s_mov_b32 m0, 27904
    s_nop 0
    buffer_load_dwordx4 v14, s[16:19], s72 offen lds
    s_mov_b32 m0, 28928
    s_nop 0
    buffer_load_dwordx4 v15, s[16:19], s72 offen lds
    s_mov_b32 m0, 29952
    s_nop 0
    buffer_load_dwordx4 v16, s[16:19], s72 offen lds
    s_mov_b32 m0, 30976
    s_nop 0
    buffer_load_dwordx4 v17, s[16:19], s72 offen lds
    s_mov_b32 m0, 32000
    s_nop 0
    buffer_load_dwordx4 v18, s[16:19], s72 offen lds
    s_mov_b32 m0, 33024
    s_nop 0
    buffer_load_dwordx4 v14, s[16:19], s73 offen lds
    s_mov_b32 m0, 34048
    ds_read_b128 v[24:27], v20 offset:16
    buffer_load_dwordx4 v15, s[16:19], s73 offen lds
    s_mov_b32 m0, 35072
    s_nop 0
    buffer_load_dwordx4 v16, s[16:19], s73 offen lds
    s_mov_b32 m0, 36096
    s_nop 0
    buffer_load_dwordx4 v17, s[16:19], s73 offen lds
    s_mov_b32 m0, 37120
    s_nop 0
    buffer_load_dwordx4 v18, s[16:19], s73 offen lds
    s_mul_i32 s72, s76, s82
    s_mov_b32 m0, 38144
    s_add_u32 s72, s72, s79
    buffer_load_dwordx4 v19, s[20:23], s72 offen lds
    s_add_u32 s76, s76, 1
    s_cmp_eq_u32 s76, 10
    s_cselect_b32 s76, 0, s76
    s_cmp_eq_u32 s76, s70
    s_addc_u32 s76, s76, 0
L_sf2:
    s_waitcnt lgkmcnt(0)
    v_min_u32 v24, v24, v25
    v_min3_u32 v24, v24, v26, v27
    s_nop 0
    v_readfirstlane_b32 s74, v24
    s_nop 0
    s_cmp_le_u32 s74, 2
    s_cbranch_scc1 L_sfr2
    s_lshl_b32 s72, s76, 7
    s_add_u32 s72, s72, s77
    s_mov_b32 m0, 39424
    s_add_u32 s73, s72, 0
    buffer_load_dwordx4 v12, s[12:15], s73 offen lds
    s_mov_b32 m0, 40448
    s_add_u32 s73, s72, 10240
    buffer_load_dwordx4 v13, s[12:15], s73 offen lds
    s_mov_b32 m0, 41472
    s_add_u32 s73, s72, 20480
    buffer_load_dwordx4 v12, s[12:15], s73 offen lds
    s_mov_b32 m0, 42496
    s_add_u32 s73, s72, 30720
    buffer_load_dwordx4 v13, s[12:15], s73 offen lds
    s_mov_b32 m0, 43520
    s_add_u32 s73, s72, 40960
    buffer_load_dwordx4 v12, s[12:15], s73 offen lds
    s_mov_b32 m0, 44544
    s_add_u32 s73, s72, 51200
    buffer_load_dwordx4 v13, s[12:15], s73 offen lds
    s_mov_b32 m0, 45568
    s_add_u32 s73, s72, 61440
    buffer_load_dwordx4 v12, s[12:15], s73 offen lds
    s_mov_b32 m0, 46592
    s_add_u32 s73, s72, 71680
    buffer_load_dwordx4 v13, s[12:15], s73 offen lds
    v_mov_b32 v21, 5
    s_waitcnt vmcnt(27)
    ds_write_b32 v20, v21
    s_mul_i32 s72, s76, 81920
    s_add_u32 s72, s72, s78
    s_add_u32 s73, s72, 40960
    s_mov_b32 m0, 47616
    s_nop 0
    buffer_load_dwordx4 v14, s[16:19], s72 offen lds
    s_mov_b32 m0, 48640
    s_nop 0
    buffer_load_dwordx4 v15, s[16:19], s72 offen lds
    s_mov_b32 m0, 49664
    s_nop 0
    buffer_load_dwordx4 v16, s[16:19], s72 offen lds
    s_mov_b32 m0, 50688
    s_nop 0
    buffer_load_dwordx4 v17, s[16:19], s72 offen lds
    s_mov_b32 m0, 51712
    s_nop 0
    buffer_load_dwordx4 v18, s[16:19], s72 offen lds
    s_mov_b32 m0, 52736
    s_nop 0
    buffer_load_dwordx4 v14, s[16:19], s73 offen lds
    s_mov_b32 m0, 53760
    ds_read_b128 v[24:27], v20 offset:16
    buffer_load_dwordx4 v15, s[16:19], s73 offen lds
    s_mov_b32 m0, 54784
    s_nop 0
    buffer_load_dwordx4 v16, s[16:19], s73 offen lds
    s_mov_b32 m0, 55808
    s_nop 0
    buffer_load_dwordx4 v17, s[16:19], s73 offen lds
    s_mov_b32 m0, 56832
    s_nop 0
    buffer_load_dwordx4 v18, s[16:19], s73 offen lds
    s_mul_i32 s72, s76, s82
    s_mov_b32 m0, 57856
    s_add_u32 s72, s72, s79
    buffer_load_dwordx4 v19, s[20:23], s72 offen lds
    s_add_u32 s76, s76, 1
    s_cmp_eq_u32 s76, 10
    s_cselect_b32 s76, 0, s76
    s_cmp_eq_u32 s76, s70
    s_addc_u32 s76, s76, 0
L_sf3:
    s_waitcnt lgkmcnt(0)
    v_min_u32 v24, v24, v25
    v_min3_u32 v24, v24, v26, v27
    s_nop 0
    v_readfirstlane_b32 s74, v24
    s_nop 0
    s_cmp_le_u32 s74, 3
    s_cbranch_scc1 L_sfr3
    s_lshl_b32 s72, s76, 7
    s_add_u32 s72, s72, s77
    s_mov_b32 m0, 59136
    s_add_u32 s73, s72, 0
    buffer_load_dwordx4 v12, s[12:15], s73 offen lds
    s_mov_b32 m0, 60160
    s_add_u32 s73, s72, 10240
    buffer_load_dwordx4 v13, s[12:15], s73 offen lds
    s_mov_b32 m0, 61184
    s_add_u32 s73, s72, 20480
    buffer_load_dwordx4 v12, s[12:15], s73 offen lds
    s_mov_b32 m0, 62208
    s_add_u32 s73, s72, 30720
    buffer_load_dwordx4 v13, s[12:15], s73 offen lds
    s_mov_b32 m0, 63232
    s_add_u32 s73, s72, 40960
    buffer_load_dwordx4 v12, s[12:15], s73 offen lds
    s_mov_b32 m0, 64256
    s_add_u32 s73, s72, 51200
    buffer_load_dwordx4 v13, s[12:15], s73 offen lds
    s_mov_b32 m0, 65280
    s_add_u32 s73, s72, 61440
    buffer_load_dwordx4 v12, s[12:15], s73 offen lds
    s_mov_b32 m0, 66304
    s_add_u32 s73, s72, 71680
    buffer_load_dwordx4 v13, s[12:15], s73 offen lds
    v_mov_b32 v21, 6
    s_waitcnt vmcnt(27)
    ds_write_b32 v20, v21
    s_mul_i32 s72, s76, 81920
    s_add_u32 s72, s72, s78
    s_add_u32 s73, s72, 40960
    s_mov_b32 m0, 67328
    s_nop 0
    buffer_load_dwordx4 v14, s[16:19], s72 offen lds
    s_mov_b32 m0, 68352
    s_nop 0
    buffer_load_dwordx4 v15, s[16:19], s72 offen lds
    s_mov_b32 m0, 69376
    s_nop 0
    buffer_load_dwordx4 v16, s[16:19], s72 offen lds
    s_mov_b32 m0, 70400
    s_nop 0
    buffer_load_dwordx4 v17, s[16:19], s72 offen lds
    s_mov_b32 m0, 71424
    s_nop 0
    buffer_load_dwordx4 v18, s[16:19], s72 offen lds
    s_mov_b32 m0, 72448
    s_nop 0
    buffer_load_dwordx4 v14, s[16:19], s73 offen lds
    s_mov_b32 m0, 73472
    ds_read_b128 v[24:27], v20 offset:16
    buffer_load_dwordx4 v15, s[16:19], s73 offen lds
    s_mov_b32 m0, 74496
    s_nop 0
    buffer_load_dwordx4 v16, s[16:19], s73 offen lds
    s_mov_b32 m0, 75520
    s_nop 0
    buffer_load_dwordx4 v17, s[16:19], s73 offen lds
    s_mov_b32 m0, 76544
    s_nop 0
    buffer_load_dwordx4 v18, s[16:19], s73 offen lds
    s_mul_i32 s72, s76, s82
    s_mov_b32 m0, 77568
    s_add_u32 s72, s72, s79
    buffer_load_dwordx4 v19, s[20:23], s72 offen lds
    s_add_u32 s76, s76, 1
    s_cmp_eq_u32 s76, 10
    s_cselect_b32 s76, 0, s76
    s_cmp_eq_u32 s76, s70
    s_addc_u32 s76, s76, 0
L_sf4:
    s_waitcnt lgkmcnt(0)
    v_min_u32 v24, v24, v25
    v_min3_u32 v24, v24, v26, v27
    s_nop 0
    v_readfirstlane_b32 s74, v24
    s_nop 0
    s_cmp_le_u32 s74, 4
    s_cbranch_scc1 L_sfr4
    s_lshl_b32 s72, s76, 7
    s_add_u32 s72, s72, s77
    s_mov_b32 m0, 0
    s_add_u32 s73, s72, 0
    buffer_load_dwordx4 v12, s[12:15], s73 offen lds
    s_mov_b32 m0, 1024
    s_add_u32 s73, s72, 10240
    buffer_load_dwordx4 v13, s[12:15], s73 offen lds
    s_mov_b32 m0, 2048
    s_add_u32 s73, s72, 20480
    buffer_load_dwordx4 v12, s[12:15], s73 offen lds
    s_mov_b32 m0, 3072
    s_add_u32 s73, s72, 30720
    buffer_load_dwordx4 v13, s[12:15], s73 offen lds
    s_mov_b32 m0, 4096
    s_add_u32 s73, s72, 40960
    buffer_load_dwordx4 v12, s[12:15], s73 offen lds
    s_mov_b32 m0, 5120
    s_add_u32 s73, s72, 51200
    buffer_load_dwordx4 v13, s[12:15], s73 offen lds
    s_mov_b32 m0, 6144
    s_add_u32 s73, s72, 61440
    buffer_load_dwordx4 v12, s[12:15], s73 offen lds
    s_mov_b32 m0, 7168
    s_add_u32 s73, s72, 71680
    buffer_load_dwordx4 v13, s[12:15], s73 offen lds
    v_mov_b32 v21, 7
    s_waitcnt vmcnt(27)
    ds_write_b32 v20, v21
    s_mul_i32 s72, s76, 81920
    s_add_u32 s72, s72, s78
    s_add_u32 s73, s72, 40960
    s_mov_b32 m0, 8192
    s_nop 0
    buffer_load_dwordx4 v14, s[16:19], s72 offen lds
    s_mov_b32 m0, 9216
    s_nop 0
    buffer_load_dwordx4 v15, s[16:19], s72 offen lds
    s_mov_b32 m0, 10240
    s_nop 0
    buffer_load_dwordx4 v16, s[16:19], s72 offen lds
    s_mov_b32 m0, 11264
    s_nop 0
    buffer_load_dwordx4 v17, s[16:19], s72 offen lds
    s_mov_b32 m0, 12288
    s_nop 0
    buffer_load_dwordx4 v18, s[16:19], s72 offen lds
    s_mov_b32 m0, 13312
    s_nop 0
    buffer_load_dwordx4 v14, s[16:19], s73 offen lds
    s_mov_b32 m0, 14336
    ds_read_b128 v[24:27], v20 offset:16
    buffer_load_dwordx4 v15, s[16:19], s73 offen lds
    s_mov_b32 m0, 15360
    s_nop 0
    buffer_load_dwordx4 v16, s[16:19], s73 offen lds
    s_mov_b32 m0, 16384
    s_nop 0
    buffer_load_dwordx4 v17, s[16:19], s73 offen lds
    s_mov_b32 m0, 17408
    s_nop 0
    buffer_load_dwordx4 v18, s[16:19], s73 offen lds
    s_mul_i32 s72, s76, s82
    s_mov_b32 m0, 18432
    s_add_u32 s72, s72, s79
    buffer_load_dwordx4 v19, s[20:23], s72 offen lds
    s_add_u32 s76, s76, 1
    s_cmp_eq_u32 s76, 10
    s_cselect_b32 s76, 0, s76
    s_cmp_eq_u32 s76, s70
    s_addc_u32 s76, s76, 0
    buffer_load_dword v29, v28, s[8:11], s80 offen sc1
L_sf5:
    s_waitcnt lgkmcnt(0)
    v_min_u32 v24, v24, v25
    v_min3_u32 v24, v24, v26, v27
    s_nop 0
    v_readfirstlane_b32 s74, v24
    s_nop 0
    s_cmp_le_u32 s74, 5
    s_cbranch_scc1 L_sfr5
    s_lshl_b32 s72, s76, 7
    s_add_u32 s72, s72, s77
    s_mov_b32 m0, 19712
    s_add_u32 s73, s72, 0
    buffer_load_dwordx4 v12, s[12:15], s73 offen lds
    s_mov_b32 m0, 20736
    s_add_u32 s73, s72, 10240
    buffer_load_dwordx4 v13, s[12:15], s73 offen lds
    s_mov_b32 m0, 21760
    s_add_u32 s73, s72, 20480
    buffer_load_dwordx4 v12, s[12:15], s73 offen lds
    s_mov_b32 m0, 22784
    s_add_u32 s73, s72, 30720
    buffer_load_dwordx4 v13, s[12:15], s73 offen lds
    s_mov_b32 m0, 23808
    s_add_u32 s73, s72, 40960
    buffer_load_dwordx4 v12, s[12:15], s73 offen lds
    s_mov_b32 m0, 24832
    s_add_u32 s73, s72, 51200
    buffer_load_dwordx4 v13, s[12:15], s73 offen lds
    s_mov_b32 m0, 25856
    s_add_u32 s73, s72, 61440
    buffer_load_dwordx4 v12, s[12:15], s73 offen lds
    s_mov_b32 m0, 26880
    s_add_u32 s73, s72, 71680
    buffer_load_dwordx4 v13, s[12:15], s73 offen lds
    v_mov_b32 v21, 8
    s_waitcnt vmcnt(28)
    ds_write_b32 v20, v21
    s_mul_i32 s72, s76, 81920
    s_add_u32 s72, s72, s78
    s_add_u32 s73, s72, 40960
    s_mov_b32 m0, 27904
    s_nop 0
    buffer_load_dwordx4 v14, s[16:19], s72 offen lds
    s_mov_b32 m0, 28928
    s_nop 0
    buffer_load_dwordx4 v15, s[16:19], s72 offen lds
    s_mov_b32 m0, 29952
    s_nop 0
    buffer_load_dwordx4 v16, s[16:19], s72 offen lds
    s_mov_b32 m0, 30976
    s_nop 0
    buffer_load_dwordx4 v17, s[16:19], s72 offen lds
    s_mov_b32 m0, 32000
    s_nop 0
    buffer_load_dwordx4 v18, s[16:19], s72 offen lds
    s_mov_b32 m0, 33024
    s_nop 0
    buffer_load_dwordx4 v14, s[16:19], s73 offen lds
    s_mov_b32 m0, 34048
    s_nop 0
    buffer_load_dwordx4 v15, s[16:19], s73 offen lds
    s_mov_b32 m0, 35072
    s_nop 0
    buffer_load_dwordx4 v16, s[16:19], s73 offen lds
    s_mov_b32 m0, 36096
    s_nop 0
    buffer_load_dwordx4 v17, s[16:19], s73 offen lds
    s_mov_b32 m0, 37120
    s_nop 0
    buffer_load_dwordx4 v18, s[16:19], s73 offen lds
    s_mul_i32 s72, s76, s82
    s_mov_b32 m0, 38144
    s_add_u32 s72, s72, s79
    buffer_load_dwordx4 v19, s[20:23], s72 offen lds
    s_add_u32 s76, s76, 1
    s_cmp_eq_u32 s76, 10
    s_cselect_b32 s76, 0, s76
    s_cmp_eq_u32 s76, s70
    s_addc_u32 s76, s76, 0
    v_mov_b32 v21, 9
    s_waitcnt vmcnt(20)
    ds_write_b32 v20, v21
    s_waitcnt vmcnt(19)
    v_cmp_ne_u32 vcc, s71, v29
    s_nop 4
    s_cbranch_vccnz L_bl0
    s_mul_i32 s72, s6, 4224
    s_add_u32 s72, s72, 0x280000
    s_mov_b32 m0, 131584
    s_nop 0
    buffer_load_dwordx4 v32, s[8:11], s72 offen sc1 lds
    s_mov_b32 m0, 132608
    s_nop 0
    buffer_load_dwordx4 v33, s[8:11], s72 offen sc1 lds
    s_mov_b32 m0, 133632
    s_nop 0
    buffer_load_dwordx4 v34, s[8:11], s72 offen sc1 lds
    s_mov_b32 m0, 134656
    s_nop 0
    buffer_load_dwordx4 v35, s[8:11], s72 offen sc1 lds
    s_mov_b32 m0, 135680
    s_nop 0
    buffer_load_dwordx4 v36, s[8:11], s72 offen sc1 lds
    s_mov_b32 m0, 136704
    s_mov_b64 exec, 0x3ffffff
    buffer_load_dwordx4 v37, s[8:11], s72 offen sc1 lds
    s_mov_b64 exec, -1
    s_add_u32 s72, s72, 4224
    s_mov_b32 m0, 139264
    s_nop 0
    buffer_load_dwordx4 v32, s[8:11], s72 offen sc1 lds
    s_mov_b32 m0, 140288
    s_nop 0
    buffer_load_dwordx4 v33, s[8:11], s72 offen sc1 lds
    s_mov_b32 m0, 141312
    s_nop 0
    buffer_load_dwordx4 v34, s[8:11], s72 offen sc1 lds
    s_mov_b32 m0, 142336
    s_nop 0
    buffer_load_dwordx4 v35, s[8:11], s72 offen sc1 lds
    s_mov_b32 m0, 143360
    s_nop 0
    buffer_load_dwordx4 v36, s[8:11], s72 offen sc1 lds
    s_mov_b32 m0, 144384
    s_mov_b64 exec, 0x3ffffff
    buffer_load_dwordx4 v37, s[8:11], s72 offen sc1 lds
    s_mov_b64 exec, -1
    s_add_u32 s72, s72, 4224
    s_mov_b32 m0, 146944
    s_nop 0
    buffer_load_dwordx4 v32, s[8:11], s72 offen sc1 lds
    s_mov_b32 m0, 147968
    s_nop 0
    buffer_load_dwordx4 v33, s[8:11], s72 offen sc1 lds
    s_mov_b32 m0, 148992
    s_nop 0
    buffer_load_dwordx4 v34, s[8:11], s72 offen sc1 lds
    s_mov_b32 m0, 150016
    s_nop 0
    buffer_load_dwordx4 v35, s[8:11], s72 offen sc1 lds
    s_mov_b32 m0, 151040
    s_nop 0
    buffer_load_dwordx4 v36, s[8:11], s72 offen sc1 lds
    s_mov_b32 m0, 152064
    s_mov_b64 exec, 0x3ffffff
    buffer_load_dwordx4 v37, s[8:11], s72 offen sc1 lds
    s_mov_b64 exec, -1
    s_add_u32 s72, s72, 4224
    v_mov_b32 v21, 10
    s_waitcnt vmcnt(18)
    ds_write_b32 v20, v21
    s_mov_b32 s87, 1
L_bl0:
    s_cmp_lg_u32 s87, 0
    s_cbranch_scc1 L_bl1
    buffer_load_dword v29, v28, s[8:11], s80 offen sc1
L_bl1:
    v_mov_b32 v21, 10
    s_waitcnt vmcnt(0)
    ds_write_b32 v20, v21
    s_cmp_lg_u32 s87, 0
    s_cbranch_scc1 L_bl2
    s_waitcnt vmcnt(0)
    s_mov_b32 s75, 100000
    s_branch L_pu_chk
L_pu_retry:
    buffer_load_dword v29, v28, s[8:11], s80 offen sc1
    s_waitcnt vmcnt(0)
L_pu_chk:
    v_cmp_ne_u32 vcc, s71, v29
    s_nop 4
    s_cbranch_vccz L_pu_ok
    s_mov_b64 exec, vcc
    s_sleep 1
    s_sub_u32 s75, s75, 1
    s_cmp_lg_u32 s75, 0
    s_cbranch_scc1 L_pu_retry
    s_endpgm
L_pu_ok:
    s_mov_b64 exec, -1
    s_mul_i32 s72, s6, 4224
    s_add_u32 s72, s72, 0x280000
    s_mov_b32 m0, 131584
    s_nop 0
    buffer_load_dwordx4 v32, s[8:11], s72 offen sc1 lds
    s_mov_b32 m0, 132608
    s_nop 0
    buffer_load_dwordx4 v33, s[8:11], s72 offen sc1 lds
    s_mov_b32 m0, 133632
    s_nop 0
    buffer_load_dwordx4 v34, s[8:11], s72 offen sc1 lds
    s_mov_b32 m0, 134656
    s_nop 0
    buffer_load_dwordx4 v35, s[8:11], s72 offen sc1 lds
    s_mov_b32 m0, 135680
    s_nop 0
    buffer_load_dwordx4 v36, s[8:11], s72 offen sc1 lds
    s_mov_b32 m0, 136704
    s_mov_b64 exec, 0x3ffffff
    buffer_load_dwordx4 v37, s[8:11], s72 offen sc1 lds
    s_mov_b64 exec, -1
    s_add_u32 s72, s72, 4224
    s_mov_b32 m0, 139264
    s_nop 0
    buffer_load_dwordx4 v32, s[8:11], s72 offen sc1 lds
    s_mov_b32 m0, 140288
    s_nop 0
    buffer_load_dwordx4 v33, s[8:11], s72 offen sc1 lds
    s_mov_b32 m0, 141312
    s_nop 0
    buffer_load_dwordx4 v34, s[8:11], s72 offen sc1 lds
    s_mov_b32 m0, 142336
    s_nop 0
    buffer_load_dwordx4 v35, s[8:11], s72 offen sc1 lds
    s_mov_b32 m0, 143360
    s_nop 0
    buffer_load_dwordx4 v36, s[8:11], s72 offen sc1 lds
    s_mov_b32 m0, 144384
    s_mov_b64 exec, 0x3ffffff
    buffer_load_dwordx4 v37, s[8:11], s72 offen sc1 lds
    s_mov_b64 exec, -1
    s_add_u32 s72, s72, 4224
    s_mov_b32 m0, 146944
    s_nop 0
    buffer_load_dwordx4 v32, s[8:11], s72 offen sc1 lds
    s_mov_b32 m0, 147968
    s_nop 0
    buffer_load_dwordx4 v33, s[8:11], s72 offen sc1 lds
    s_mov_b32 m0, 148992
    s_nop 0
    buffer_load_dwordx4 v34, s[8:11], s72 offen sc1 lds
    s_mov_b32 m0, 150016
    s_nop 0
    buffer_load_dwordx4 v35, s[8:11], s72 offen sc1 lds
    s_mov_b32 m0, 151040
    s_nop 0
    buffer_load_dwordx4 v36, s[8:11], s72 offen sc1 lds
    s_mov_b32 m0, 152064
    s_mov_b64 exec, 0x3ffffff
    buffer_load_dwordx4 v37, s[8:11], s72 offen sc1 lds
    s_mov_b64 exec, -1
    s_add_u32 s72, s72, 4224
    s_waitcnt vmcnt(0)
L_bl2:
    v_mov_b32 v21, 10
    ds_write_b32 v20, v21 offset:44
    s_mov_b32 s87, 0
    s_setprio 0
    v_cmp_eq_u32 vcc, 20, v2
    v_mov_b32 v6, 0x3f803f80
    v_mov_b32 v128, v6
    v_mov_b32 v129, v6
    v_mov_b32 v130, v6
    v_mov_b32 v131, v6
    v_mov_b32 v132, v6
    v_mov_b32 v133, v6
    v_mov_b32 v134, v6
    v_mov_b32 v135, v6
    v_mov_b32 v136, v6
    v_mov_b32 v137, v6
    v_mov_b32 v138, v6
    v_mov_b32 v139, v6
    v_mov_b32 v140, v6
    v_mov_b32 v141, v6
    v_mov_b32 v142, v6
    v_mov_b32 v143, v6
    v_cndmask_b32 v5, 0, v6, vcc
    v_mov_b32 v144, v5
    v_mov_b32 v145, v5
    v_mov_b32 v146, v5
    v_mov_b32 v147, v5
    v_mov_b32 v148, v5
    v_mov_b32 v149, v5
    v_mov_b32 v150, v5
    v_mov_b32 v151, v5
    v_mov_b32 v152, v5
    v_mov_b32 v153, v5
    v_mov_b32 v154, v5
    v_mov_b32 v155, v5
    v_mov_b32 v156, v5
    v_mov_b32 v157, v5
    v_mov_b32 v158, v5
    v_mov_b32 v159, v5
    v_mov_b32 v160, v5
    v_mov_b32 v161, v5
    v_mov_b32 v162, v5
    v_mov_b32 v163, v5
    v_mov_b32 v164, v5
    v_mov_b32 v165, v5
    v_mov_b32 v166, v5
    v_mov_b32 v167, v5
    v_mov_b32 v168, v5
    v_mov_b32 v169, v5
    v_mov_b32 v170, v5
    v_mov_b32 v171, v5
    v_mov_b32 v172, v5
    v_mov_b32 v173, v5
    v_mov_b32 v174, v5
    v_mov_b32 v175, v5
    v_mov_b32 v176, v5
    v_mov_b32 v177, v5
    v_mov_b32 v178, v5
    v_mov_b32 v179, v5
    v_mov_b32 v180, v5
    v_mov_b32 v181, v5
    v_mov_b32 v182, v5
    v_mov_b32 v183, v5
    v_mov_b32 v184, v5
    v_mov_b32 v185, v5
    v_mov_b32 v186, v5
    v_mov_b32 v187, v5
    v_mov_b32 v188, v5
    v_mov_b32 v189, v5
    v_mov_b32 v190, v5
    v_mov_b32 v191, v5
    v_mov_b32 v192, v5
    v_mov_b32 v193, v5
    v_mov_b32 v194, v5
    v_mov_b32 v195, v5
    v_mov_b32 v196, v5
    v_mov_b32 v197, v5
    v_mov_b32 v198, v5
    v_mov_b32 v199, v5
    v_mov_b32 v200, v5
    v_mov_b32 v201, v5
    v_mov_b32 v202, v5
    v_mov_b32 v203, v5
    v_mov_b32 v204, v5
    v_mov_b32 v205, v5
    v_mov_b32 v206, v5
    v_mov_b32 v207, v5
    s_branch L_join
L_gemm:
    s_setprio 2
    s_sub_u32 s93, s68, 4
    v_bfe_u32 v6, v1, 1, 3
    v_xor_b32 v6, v6, v3
    v_lshlrev_b32 v6, 4, v6
    v_lshl_add_u32 v100, v2, 7, v6
    v_xor_b32 v101, 32, v100
    v_xor_b32 v102, 64, v100
    v_xor_b32 v103, 96, v100
    v_bfe_u32 v5, v1, 2, 2
    v_lshl_add_u32 v12, v3, 2, v5
    v_mul_u32_u24 v12, 320, v12
    s_mul_i32 s72, s93, 40
    s_add_u32 s72, s72, 8192
    v_add_u32 v12, s72, v12
    v_and_b32 v6, 3, v1
    v_lshlrev_b32 v6, 3, v6
    v_mov_b32 v13, 2560
    v_mov_b32 v14, 160
    v_add_u32 v12, v12, v6
    s_mov_b32 exec_lo, 0xffff0000
    s_mov_b32 exec_hi, 0xffff0000
    v_add_u32 v12, 32, v12
    v_lshl_add_u32 v5, v3, 3, v5
    v_lshlrev_b32 v5, 4, v5
    s_mul_i32 s72, s93, 40
    s_add_u32 s72, s72, 40
    s_and_b32 s72, s72, 63
    s_add_u32 s72, s72, 19456
    s_mov_b32 exec_lo, 0xeeee0000
    s_mov_b32 exec_hi, 0xeeee0000
    v_mov_b32 v12, s72
    v_mov_b32 v13, 0
    v_mov_b32 v14, 32
    s_cmp_eq_u32 s93, 0
    s_cselect_b32 exec_lo, 0xcccc0000, 0
    s_cselect_b32 exec_hi, 0xcccc0000, 0
    v_add3_u32 v12, v5, v6, -16
    v_add_u32 v12, 18432, v12
    v_mov_b32 v13, 256
    v_mov_b32 v14, 64
    s_mov_b64 exec, -1
    v_mad_u32_u24 v104, v13, 0, v12
    v_add_u32 v105, v104, v14
    v_mad_u32_u24 v106, v13, 1, v12
    v_add_u32 v107, v106, v14
    v_mad_u32_u24 v108, v13, 2, v12
    v_add_u32 v109, v108, v14
    v_mad_u32_u24 v110, v13, 3, v12
    v_add_u32 v111, v110, v14
    v_mov_b32 v112, 153856
    s_lshl_b32 s72, s93, 2
    s_add_u32 s72, s72, 153872
    v_mov_b32 v113, s72
    v_lshrrev_b32 v5, 4, v1
    v_bfe_u32 v6, v1, 2, 2
    v_lshl_add_u32 v6, v5, 3, v6
    v_bfe_u32 v117, v6, 1, 3
    s_lshl_b32 s72, s93, 1
    v_xor_b32 v117, s72, v117
    v_lshlrev_b32 v117, 4, v117
    v_lshl_add_u32 v116, v6, 7, v117
    v_and_b32 v6, 1, v1
    v_lshl_add_u32 v116, v6, 3, v116
    v_bfe_u32 v6, v1, 1, 1
    v_lshl_add_u32 v116, v6, 12, v116
    v_xor_b32 v117, 32, v116
    v_xor_b32 v118, 16, v116
    v_xor_b32 v119, 48, v116
    v_and_b32 v6, 7, v1
    v_mul_u32_u24 v6, 4224, v6
    v_lshl_add_u32 v120, v5, 4, v6
    v_bfe_u32 v6, v1, 3, 1
    v_lshl_add_u32 v120, v6, 6, v120
    v_add_u32 v121, 33792, v120
    s_lshl_b32 s80, s70, 2
    s_add_u32 s80, s80, s93
    s_mul_i32 s81, s80, 67584
    s_lshl_b32 s72, s69, 7
    s_add_u32 s81, s81, s72
    s_add_u32 s81, s81, 0x280000
    v_cmp_eq_u32 vcc, 20, v2
    v_mov_b32 v6, 0x3f803f80
    v_mov_b32 v128, v6
    v_mov_b32 v129, v6
    v_mov_b32 v130, v6
    v_mov_b32 v131, v6
    v_mov_b32 v132, v6
    v_mov_b32 v133, v6
    v_mov_b32 v134, v6
    v_mov_b32 v135, v6
    v_mov_b32 v136, v6
    v_mov_b32 v137, v6
    v_mov_b32 v138, v6
    v_mov_b32 v139, v6
    v_mov_b32 v140, v6
    v_mov_b32 v141, v6
    v_mov_b32 v142, v6
    v_mov_b32 v143, v6
    v_cndmask_b32 v5, 0, v6, vcc
    v_mov_b32 v144, v5
    v_mov_b32 v145, v5
    v_mov_b32 v146, v5
    v_mov_b32 v147, v5
    v_mov_b32 v148, v5
    v_mov_b32 v149, v5
    v_mov_b32 v150, v5
    v_mov_b32 v151, v5
    v_mov_b32 v152, v5
    v_mov_b32 v153, v5
    v_mov_b32 v154, v5
    v_mov_b32 v155, v5
    v_mov_b32 v156, v5
    v_mov_b32 v157, v5
    v_mov_b32 v158, v5
    v_mov_b32 v159, v5
    v_mov_b32 v160, v5
    v_mov_b32 v161, v5
    v_mov_b32 v162, v5
    v_mov_b32 v163, v5
    v_mov_b32 v164, v5
    v_mov_b32 v165, v5
    v_mov_b32 v166, v5
    v_mov_b32 v167, v5
    v_mov_b32 v168, v5
    v_mov_b32 v169, v5
    v_mov_b32 v170, v5
    v_mov_b32 v171, v5
    v_mov_b32 v172, v5
    v_mov_b32 v173, v5
    v_mov_b32 v174, v5
    v_mov_b32 v175, v5
    v_mov_b32 v176, v5
    v_mov_b32 v177, v5
    v_mov_b32 v178, v5
    v_mov_b32 v179, v5
    v_mov_b32 v180, v5
    v_mov_b32 v181, v5
    v_mov_b32 v182, v5
    v_mov_b32 v183, v5
    v_mov_b32 v184, v5
    v_mov_b32 v185, v5
    v_mov_b32 v186, v5
    v_mov_b32 v187, v5
    v_mov_b32 v188, v5
    v_mov_b32 v189, v5
    v_mov_b32 v190, v5
    v_mov_b32 v191, v5
    v_mov_b32 v192, v5
    v_mov_b32 v193, v5
    v_mov_b32 v194, v5
    v_mov_b32 v195, v5
    v_mov_b32 v196, v5
    v_mov_b32 v197, v5
    v_mov_b32 v198, v5
    v_mov_b32 v199, v5
    v_mov_b32 v200, v5
    v_mov_b32 v201, v5
    v_mov_b32 v202, v5
    v_mov_b32 v203, v5
    v_mov_b32 v204, v5
    v_mov_b32 v205, v5
    v_mov_b32 v206, v5
    v_mov_b32 v207, v5
    s_waitcnt lgkmcnt(0)
    s_mul_i32 s71, s71, 0x9e3779b1
    s_add_u32 s71, s71, 0x7f4a7c15
    s_mov_b32 s75, 3000000
    v_mov_b32 v114, 0
L_gc0:
    s_nop 0
    v_readfirstlane_b32 s72, v114
    v_mov_b32 v115, 1
    s_cmp_le_u32 s72, 0
    s_cbranch_scc1 L_gp0
    ds_read_b64_tr_b16 v[44:45], v104 offset:0
    ds_read_b64_tr_b16 v[46:47], v105 offset:0
    ds_read_b128 v[60:63], v100 offset:0
    ds_read_b128 v[64:67], v100 offset:4096
    ds_read_b64_tr_b16 v[48:49], v106 offset:0
    ds_read_b64_tr_b16 v[50:51], v107 offset:0
    ds_read_b128 v[68:71], v101 offset:0
    ds_read_b128 v[72:75], v101 offset:4096
    ds_read_b64_tr_b16 v[92:93], v116 offset:0
    ds_read_b64_tr_b16 v[94:95], v117 offset:512
    ds_read_b64_tr_b16 v[96:97], v118 offset:0
    ds_read_b64_tr_b16 v[98:99], v119 offset:512
    ds_read_b64_tr_b16 v[52:53], v108 offset:0
    ds_read_b64_tr_b16 v[54:55], v109 offset:0
    ds_read_b128 v[76:79], v102 offset:0
    ds_read_b128 v[80:83], v102 offset:4096
    ds_read_b32 v114, v112
    s_waitcnt lgkmcnt(13)
    v_mfma_f32_32x32x16_bf16 v[12:27], v[44:47], v[60:63], 0
    v_mfma_f32_32x32x16_bf16 v[28:43], v[44:47], v[64:67], 0
    ds_read_b64_tr_b16 v[56:57], v110 offset:0
    ds_read_b64_tr_b16 v[58:59], v111 offset:0
    ds_read_b128 v[84:87], v103 offset:0
    ds_read_b128 v[88:91], v103 offset:4096
    ds_write_b32 v113, v115
    s_waitcnt lgkmcnt(14)
    v_mfma_f32_32x32x16_bf16 v[12:27], v[48:51], v[68:71], v[12:27]
    v_mfma_f32_32x32x16_bf16 v[28:43], v[48:51], v[72:75], v[28:43]
    s_waitcnt lgkmcnt(10)
    buffer_store_dwordx4 v[92:95], v120, s[8:11], s81 offen sc1
    buffer_store_dwordx4 v[96:99], v121, s[8:11], s81 offen sc1
    s_waitcnt lgkmcnt(5)
L_gc1:
    v_readfirstlane_b32 s72, v114
    v_mov_b32 v115, 2
    s_cmp_le_u32 s72, 1
    s_cbranch_scc1 L_gp1
    ds_read_b64_tr_b16 v[44:45], v104 offset:19712
    ds_read_b64_tr_b16 v[46:47], v105 offset:19712
    ds_read_b128 v[60:63], v100 offset:19712
    ds_read_b128 v[64:67], v100 offset:23808
    v_mfma_f32_32x32x16_bf16 v[12:27], v[52:55], v[76:79], v[12:27]
    v_mfma_f32_32x32x16_bf16 v[28:43], v[52:55], v[80:83], v[28:43]
    ds_read_b64_tr_b16 v[48:49], v106 offset:19712
    ds_read_b64_tr_b16 v[50:51], v107 offset:19712
    ds_read_b128 v[68:71], v101 offset:19712
    ds_read_b128 v[72:75], v101 offset:23808
    ds_read_b64_tr_b16 v[92:93], v116 offset:19712
    ds_read_b64_tr_b16 v[94:95], v117 offset:20224
    ds_read_b64_tr_b16 v[96:97], v118 offset:19712
    ds_read_b64_tr_b16 v[98:99], v119 offset:20224
    s_waitcnt lgkmcnt(13)
    v_mfma_f32_32x32x16_bf16 v[12:27], v[56:59], v[84:87], v[12:27]
    v_mfma_f32_32x32x16_bf16 v[28:43], v[56:59], v[88:91], v[28:43]
    ds_read_b64_tr_b16 v[52:53], v108 offset:19712
    ds_read_b64_tr_b16 v[54:55], v109 offset:19712
    ds_read_b128 v[76:79], v102 offset:19712
    ds_read_b128 v[80:83], v102 offset:23808
    ds_read_b32 v114, v112
    s_waitcnt lgkmcnt(13)
    v_mfma_f32_32x32x16_bf16 v[12:27], v[44:47], v[60:63], v[12:27]
    v_mfma_f32_32x32x16_bf16 v[28:43], v[44:47], v[64:67], v[28:43]
    ds_read_b64_tr_b16 v[56:57], v110 offset:19712
    ds_read_b64_tr_b16 v[58:59], v111 offset:19712
    ds_read_b128 v[84:87], v103 offset:19712
    ds_read_b128 v[88:91], v103 offset:23808
    ds_write_b32 v113, v115
    s_waitcnt lgkmcnt(14)
    v_mfma_f32_32x32x16_bf16 v[12:27], v[48:51], v[68:71], v[12:27]
    v_mfma_f32_32x32x16_bf16 v[28:43], v[48:51], v[72:75], v[28:43]
    s_waitcnt lgkmcnt(10)
    s_cmp_lt_u32 s86, 8
    s_cbranch_scc1 L_nut
    s_sub_u32 s72, s86, s70
    s_mul_i32 s72, s72, 270336
    s_add_u32 s81, s81, s72
    buffer_store_dwordx4 v[92:95], v120, s[8:11], s81 offen sc1
    buffer_store_dwordx4 v[96:99], v121, s[8:11], s81 offen sc1
L_nut:
    s_waitcnt lgkmcnt(5)
L_gc2:
    v_readfirstlane_b32 s72, v114
    v_mov_b32 v115, 3
    s_cmp_le_u32 s72, 2
    s_cbranch_scc1 L_gp2
    ds_read_b64_tr_b16 v[44:45], v104 offset:39424
    ds_read_b64_tr_b16 v[46:47], v105 offset:39424
    ds_read_b128 v[60:63], v100 offset:39424
    ds_read_b128 v[64:67], v100 offset:43520
    v_mfma_f32_32x32x16_bf16 v[12:27], v[52:55], v[76:79], v[12:27]
    v_mfma_f32_32x32x16_bf16 v[28:43], v[52:55], v[80:83], v[28:43]
    ds_read_b64_tr_b16 v[48:49], v106 offset:39424
    ds_read_b64_tr_b16 v[50:51], v107 offset:39424
    ds_read_b128 v[68:71], v101 offset:39424
    ds_read_b128 v[72:75], v101 offset:43520
    s_waitcnt lgkmcnt(9)
    v_mfma_f32_32x32x16_bf16 v[12:27], v[56:59], v[84:87], v[12:27]
    v_mfma_f32_32x32x16_bf16 v[28:43], v[56:59], v[88:91], v[28:43]
    ds_read_b64_tr_b16 v[52:53], v108 offset:39424
    ds_read_b64_tr_b16 v[54:55], v109 offset:39424
    ds_read_b128 v[76:79], v102 offset:39424
    ds_read_b128 v[80:83], v102 offset:43520
    ds_read_b32 v114, v112
    s_waitcnt lgkmcnt(9)
    v_mfma_f32_32x32x16_bf16 v[12:27], v[44:47], v[60:63], v[12:27]
    v_mfma_f32_32x32x16_bf16 v[28:43], v[44:47], v[64:67], v[28:43]
    ds_read_b64_tr_b16 v[56:57], v110 offset:39424
    ds_read_b64_tr_b16 v[58:59], v111 offset:39424
    ds_read_b128 v[84:87], v103 offset:39424
    ds_read_b128 v[88:91], v103 offset:43520
    ds_write_b32 v113, v115
    s_waitcnt lgkmcnt(10)
    v_mfma_f32_32x32x16_bf16 v[12:27], v[48:51], v[68:71], v[12:27]
    v_mfma_f32_32x32x16_bf16 v[28:43], v[48:51], v[72:75], v[28:43]
    s_waitcnt vmcnt(0)
    s_lshl_b32 s72, s80, 5
    s_add_u32 s72, s72, s69
    s_lshl_b32 s74, s72, 7
    s_add_u32 s74, s74, 0x780000
    v_mov_b32 v7, s71
    v_lshlrev_b32 v8, 2, v1
    s_mov_b32 exec_hi, 0
    buffer_store_dword v7, v8, s[8:11], s74 offen sc1
    s_mov_b64 exec, -1
    s_cmp_lt_u32 s86, 8
    s_cbranch_scc1 L_nut2
    s_sub_u32 s73, s86, s70
    s_lshl_b32 s73, s73, 7
    s_add_u32 s72, s72, s73
    s_lshl_b32 s74, s72, 7
    s_add_u32 s74, s74, 0x780000
    v_mov_b32 v7, s71
    v_lshlrev_b32 v8, 2, v1
    s_mov_b32 exec_hi, 0
    buffer_store_dword v7, v8, s[8:11], s74 offen sc1
    s_mov_b64 exec, -1
L_nut2:
    s_waitcnt lgkmcnt(5)
L_gc3:
    v_readfirstlane_b32 s72, v114
    v_mov_b32 v115, 4
    s_cmp_le_u32 s72, 3
    s_cbranch_scc1 L_gp3
    ds_read_b64_tr_b16 v[44:45], v104 offset:59136
    ds_read_b64_tr_b16 v[46:47], v105 offset:59136
    ds_read_b128 v[60:63], v100 offset:59136
    ds_read_b128 v[64:67], v100 offset:63232
    v_mfma_f32_32x32x16_bf16 v[12:27], v[52:55], v[76:79], v[12:27]
    v_mfma_f32_32x32x16_bf16 v[28:43], v[52:55], v[80:83], v[28:43]
    ds_read_b64_tr_b16 v[48:49], v106 offset:59136
    ds_read_b64_tr_b16 v[50:51], v107 offset:59136
    ds_read_b128 v[68:71], v101 offset:59136
    ds_read_b128 v[72:75], v101 offset:63232
    s_waitcnt lgkmcnt(9)
    v_mfma_f32_32x32x16_bf16 v[12:27], v[56:59], v[84:87], v[12:27]
    v_mfma_f32_32x32x16_bf16 v[28:43], v[56:59], v[88:91], v[28:43]
    ds_read_b64_tr_b16 v[52:53], v108 offset:59136
    ds_read_b64_tr_b16 v[54:55], v109 offset:59136
    ds_read_b128 v[76:79], v102 offset:59136
    ds_read_b128 v[80:83], v102 offset:63232
    ds_read_b32 v114, v112
    s_waitcnt lgkmcnt(9)
    v_mfma_f32_32x32x16_bf16 v[12:27], v[44:47], v[60:63], v[12:27]
    v_mfma_f32_32x32x16_bf16 v[28:43], v[44:47], v[64:67], v[28:43]
    ds_read_b64_tr_b16 v[56:57], v110 offset:59136
    ds_read_b64_tr_b16 v[58:59], v111 offset:59136
    ds_read_b128 v[84:87], v103 offset:59136
    ds_read_b128 v[88:91], v103 offset:63232
    ds_write_b32 v113, v115
    s_waitcnt lgkmcnt(10)
    v_mfma_f32_32x32x16_bf16 v[12:27], v[48:51], v[68:71], v[12:27]
    v_mfma_f32_32x32x16_bf16 v[28:43], v[48:51], v[72:75], v[28:43]
    s_waitcnt lgkmcnt(5)
L_gc4:
    v_readfirstlane_b32 s72, v114
    v_mov_b32 v115, 5
    s_cmp_le_u32 s72, 4
    s_cbranch_scc1 L_gp4
    ds_read_b64_tr_b16 v[44:45], v104 offset:0
    ds_read_b64_tr_b16 v[46:47], v105 offset:0
    ds_read_b128 v[60:63], v100 offset:0
    ds_read_b128 v[64:67], v100 offset:4096
    v_mfma_f32_32x32x16_bf16 v[12:27], v[52:55], v[76:79], v[12:27]
    v_mfma_f32_32x32x16_bf16 v[28:43], v[52:55], v[80:83], v[28:43]
    ds_read_b64_tr_b16 v[48:49], v106 offset:0
    ds_read_b64_tr_b16 v[50:51], v107 offset:0
    ds_read_b128 v[68:71], v101 offset:0
    ds_read_b128 v[72:75], v101 offset:4096
    s_waitcnt lgkmcnt(9)
    v_mfma_f32_32x32x16_bf16 v[12:27], v[56:59], v[84:87], v[12:27]
    v_mfma_f32_32x32x16_bf16 v[28:43], v[56:59], v[88:91], v[28:43]
    ds_read_b64_tr_b16 v[52:53], v108 offset:0
    ds_read_b64_tr_b16 v[54:55], v109 offset:0
    ds_read_b128 v[76:79], v102 offset:0
    ds_read_b128 v[80:83], v102 offset:4096
    ds_read_b32 v114, v112
    s_waitcnt lgkmcnt(9)
    v_mfma_f32_32x32x16_bf16 v[12:27], v[44:47], v[60:63], v[12:27]
    v_mfma_f32_32x32x16_bf16 v[28:43], v[44:47], v[64:67], v[28:43]
    ds_read_b64_tr_b16 v[56:57], v110 offset:0
    ds_read_b64_tr_b16 v[58:59], v111 offset:0
    ds_read_b128 v[84:87], v103 offset:0
    ds_read_b128 v[88:91], v103 offset:4096
    ds_write_b32 v113, v115
    s_waitcnt lgkmcnt(10)
    v_mfma_f32_32x32x16_bf16 v[12:27], v[48:51], v[68:71], v[12:27]
    v_mfma_f32_32x32x16_bf16 v[28:43], v[48:51], v[72:75], v[28:43]
    s_waitcnt lgkmcnt(5)
L_gc5:
    v_readfirstlane_b32 s72, v114
    v_mov_b32 v115, 6
    s_cmp_le_u32 s72, 5
    s_cbranch_scc1 L_gp5
    ds_read_b64_tr_b16 v[44:45], v104 offset:19712
    ds_read_b64_tr_b16 v[46:47], v105 offset:19712
    ds_read_b128 v[60:63], v100 offset:19712
    ds_read_b128 v[64:67], v100 offset:23808
    v_mfma_f32_32x32x16_bf16 v[12:27], v[52:55], v[76:79], v[12:27]
    v_mfma_f32_32x32x16_bf16 v[28:43], v[52:55], v[80:83], v[28:43]
    ds_read_b64_tr_b16 v[48:49], v106 offset:19712
    ds_read_b64_tr_b16 v[50:51], v107 offset:19712
    ds_read_b128 v[68:71], v101 offset:19712
    ds_read_b128 v[72:75], v101 offset:23808
    s_waitcnt lgkmcnt(9)
    v_mfma_f32_32x32x16_bf16 v[12:27], v[56:59], v[84:87], v[12:27]
    v_mfma_f32_32x32x16_bf16 v[28:43], v[56:59], v[88:91], v[28:43]
    ds_read_b64_tr_b16 v[52:53], v108 offset:19712
    ds_read_b64_tr_b16 v[54:55], v109 offset:19712
    ds_read_b128 v[76:79], v102 offset:19712
    ds_read_b128 v[80:83], v102 offset:23808
    ds_read_b32 v114, v112
    s_waitcnt lgkmcnt(9)
    v_mfma_f32_32x32x16_bf16 v[12:27], v[44:47], v[60:63], v[12:27]
    v_mfma_f32_32x32x16_bf16 v[28:43], v[44:47], v[64:67], v[28:43]
    ds_read_b64_tr_b16 v[56:57], v110 offset:19712
    ds_read_b64_tr_b16 v[58:59], v111 offset:19712
    ds_read_b128 v[84:87], v103 offset:19712
    ds_read_b128 v[88:91], v103 offset:23808
    ds_write_b32 v113, v115
    s_waitcnt lgkmcnt(10)
    v_mfma_f32_32x32x16_bf16 v[12:27], v[48:51], v[68:71], v[12:27]
    v_mfma_f32_32x32x16_bf16 v[28:43], v[48:51], v[72:75], v[28:43]
    s_waitcnt lgkmcnt(5)
L_gc6:
    v_readfirstlane_b32 s72, v114
    v_mov_b32 v115, 7
    s_cmp_le_u32 s72, 6
    s_cbranch_scc1 L_gp6
    ds_read_b64_tr_b16 v[44:45], v104 offset:39424
    ds_read_b64_tr_b16 v[46:47], v105 offset:39424
    ds_read_b128 v[60:63], v100 offset:39424
    ds_read_b128 v[64:67], v100 offset:43520
    v_mfma_f32_32x32x16_bf16 v[12:27], v[52:55], v[76:79], v[12:27]
    v_mfma_f32_32x32x16_bf16 v[28:43], v[52:55], v[80:83], v[28:43]
    ds_read_b64_tr_b16 v[48:49], v106 offset:39424
    ds_read_b64_tr_b16 v[50:51], v107 offset:39424
    ds_read_b128 v[68:71], v101 offset:39424
    ds_read_b128 v[72:75], v101 offset:43520
    s_waitcnt lgkmcnt(9)
    v_mfma_f32_32x32x16_bf16 v[12:27], v[56:59], v[84:87], v[12:27]
    v_mfma_f32_32x32x16_bf16 v[28:43], v[56:59], v[88:91], v[28:43]
    ds_read_b64_tr_b16 v[52:53], v108 offset:39424
    ds_read_b64_tr_b16 v[54:55], v109 offset:39424
    ds_read_b128 v[76:79], v102 offset:39424
    ds_read_b128 v[80:83], v102 offset:43520
    ds_read_b32 v114, v112
    s_waitcnt lgkmcnt(9)
    v_mfma_f32_32x32x16_bf16 v[12:27], v[44:47], v[60:63], v[12:27]
    v_mfma_f32_32x32x16_bf16 v[28:43], v[44:47], v[64:67], v[28:43]
    ds_read_b64_tr_b16 v[56:57], v110 offset:39424
    ds_read_b64_tr_b16 v[58:59], v111 offset:39424
    ds_read_b128 v[84:87], v103 offset:39424
    ds_read_b128 v[88:91], v103 offset:43520
    ds_write_b32 v113, v115
    s_waitcnt lgkmcnt(10)
    v_mfma_f32_32x32x16_bf16 v[12:27], v[48:51], v[68:71], v[12:27]
    v_mfma_f32_32x32x16_bf16 v[28:43], v[48:51], v[72:75], v[28:43]
    s_waitcnt lgkmcnt(5)
L_gc7:
    v_readfirstlane_b32 s72, v114
    v_mov_b32 v115, 8
    s_cmp_le_u32 s72, 7
    s_cbranch_scc1 L_gp7
    ds_read_b64_tr_b16 v[44:45], v104 offset:59136
    ds_read_b64_tr_b16 v[46:47], v105 offset:59136
    ds_read_b128 v[60:63], v100 offset:59136
    ds_read_b128 v[64:67], v100 offset:63232
    v_mfma_f32_32x32x16_bf16 v[12:27], v[52:55], v[76:79], v[12:27]
    v_mfma_f32_32x32x16_bf16 v[28:43], v[52:55], v[80:83], v[28:43]
    ds_read_b64_tr_b16 v[48:49], v106 offset:59136
    ds_read_b64_tr_b16 v[50:51], v107 offset:59136
    ds_read_b128 v[68:71], v101 offset:59136
    ds_read_b128 v[72:75], v101 offset:63232
    s_waitcnt lgkmcnt(9)
    v_mfma_f32_32x32x16_bf16 v[12:27], v[56:59], v[84:87], v[12:27]
    v_mfma_f32_32x32x16_bf16 v[28:43], v[56:59], v[88:91], v[28:43]
    ds_read_b64_tr_b16 v[52:53], v108 offset:59136
    ds_read_b64_tr_b16 v[54:55], v109 offset:59136
    ds_read_b128 v[76:79], v102 offset:59136
    ds_read_b128 v[80:83], v102 offset:63232
    ds_read_b32 v114, v112
    s_waitcnt lgkmcnt(9)
    v_mfma_f32_32x32x16_bf16 v[12:27], v[44:47], v[60:63], v[12:27]
    v_mfma_f32_32x32x16_bf16 v[28:43], v[44:47], v[64:67], v[28:43]
    ds_read_b64_tr_b16 v[56:57], v110 offset:59136
    ds_read_b64_tr_b16 v[58:59], v111 offset:59136
    ds_read_b128 v[84:87], v103 offset:59136
    ds_read_b128 v[88:91], v103 offset:63232
    ds_write_b32 v113, v115
    s_waitcnt lgkmcnt(10)
    v_mfma_f32_32x32x16_bf16 v[12:27], v[48:51], v[68:71], v[12:27]
    v_mfma_f32_32x32x16_bf16 v[28:43], v[48:51], v[72:75], v[28:43]
    s_waitcnt lgkmcnt(5)
L_gc8:
    v_readfirstlane_b32 s72, v114
    v_mov_b32 v115, 9
    s_cmp_le_u32 s72, 8
    s_cbranch_scc1 L_gp8
    ds_read_b64_tr_b16 v[44:45], v104 offset:0
    ds_read_b64_tr_b16 v[46:47], v105 offset:0
    ds_read_b128 v[60:63], v100 offset:0
    ds_read_b128 v[64:67], v100 offset:4096
    v_mfma_f32_32x32x16_bf16 v[12:27], v[52:55], v[76:79], v[12:27]
    v_mfma_f32_32x32x16_bf16 v[28:43], v[52:55], v[80:83], v[28:43]
    ds_read_b64_tr_b16 v[48:49], v106 offset:0
    ds_read_b64_tr_b16 v[50:51], v107 offset:0
    ds_read_b128 v[68:71], v101 offset:0
    ds_read_b128 v[72:75], v101 offset:4096
    s_waitcnt lgkmcnt(9)
    v_mfma_f32_32x32x16_bf16 v[12:27], v[56:59], v[84:87], v[12:27]
    v_mfma_f32_32x32x16_bf16 v[28:43], v[56:59], v[88:91], v[28:43]
    ds_read_b64_tr_b16 v[52:53], v108 offset:0
    ds_read_b64_tr_b16 v[54:55], v109 offset:0
    ds_read_b128 v[76:79], v102 offset:0
    ds_read_b128 v[80:83], v102 offset:4096
    ds_read_b32 v114, v112
    s_waitcnt lgkmcnt(9)
    v_mfma_f32_32x32x16_bf16 v[12:27], v[44:47], v[60:63], v[12:27]
    v_mfma_f32_32x32x16_bf16 v[28:43], v[44:47], v[64:67], v[28:43]
    ds_read_b64_tr_b16 v[56:57], v110 offset:0
    ds_read_b64_tr_b16 v[58:59], v111 offset:0
    ds_read_b128 v[84:87], v103 offset:0
    ds_read_b128 v[88:91], v103 offset:4096
    ds_write_b32 v113, v115
    s_waitcnt lgkmcnt(10)
    v_mfma_f32_32x32x16_bf16 v[12:27], v[48:51], v[68:71], v[12:27]
    v_mfma_f32_32x32x16_bf16 v[28:43], v[48:51], v[72:75], v[28:43]
    s_waitcnt lgkmcnt(5)
L_gc9:
    v_readfirstlane_b32 s72, v114
    v_mov_b32 v115, 10
    s_cmp_le_u32 s72, 9
    s_cbranch_scc1 L_gp9
    ds_read_b64_tr_b16 v[44:45], v104 offset:19712
    ds_read_b64_tr_b16 v[46:47], v105 offset:19712
    ds_read_b128 v[60:63], v100 offset:19712
    ds_read_b128 v[64:67], v100 offset:23808
    v_mfma_f32_32x32x16_bf16 v[12:27], v[52:55], v[76:79], v[12:27]
    v_mfma_f32_32x32x16_bf16 v[28:43], v[52:55], v[80:83], v[28:43]
    ds_read_b64_tr_b16 v[48:49], v106 offset:19712
    ds_read_b64_tr_b16 v[50:51], v107 offset:19712
    ds_read_b128 v[68:71], v101 offset:19712
    ds_read_b128 v[72:75], v101 offset:23808
    s_waitcnt lgkmcnt(9)
    v_mfma_f32_32x32x16_bf16 v[12:27], v[56:59], v[84:87], v[12:27]
    v_mfma_f32_32x32x16_bf16 v[28:43], v[56:59], v[88:91], v[28:43]
    ds_read_b64_tr_b16 v[52:53], v108 offset:19712
    ds_read_b64_tr_b16 v[54:55], v109 offset:19712
    ds_read_b128 v[76:79], v102 offset:19712
    ds_read_b128 v[80:83], v102 offset:23808
    s_waitcnt lgkmcnt(8)
    v_mfma_f32_32x32x16_bf16 v[12:27], v[44:47], v[60:63], v[12:27]
    v_mfma_f32_32x32x16_bf16 v[28:43], v[44:47], v[64:67], v[28:43]
    ds_read_b64_tr_b16 v[56:57], v110 offset:19712
    ds_read_b64_tr_b16 v[58:59], v111 offset:19712
    ds_read_b128 v[84:87], v103 offset:19712
    ds_read_b128 v[88:91], v103 offset:23808
    ds_write_b32 v113, v115
    s_waitcnt lgkmcnt(9)
    v_mfma_f32_32x32x16_bf16 v[12:27], v[48:51], v[68:71], v[12:27]
    v_mfma_f32_32x32x16_bf16 v[28:43], v[48:51], v[72:75], v[28:43]
    s_waitcnt lgkmcnt(5)
    v_mfma_f32_32x32x16_bf16 v[12:27], v[52:55], v[76:79], v[12:27]
    v_mfma_f32_32x32x16_bf16 v[28:43], v[52:55], v[80:83], v[28:43]
    s_waitcnt lgkmcnt(1)
    v_mfma_f32_32x32x16_bf16 v[12:27], v[56:59], v[84:87], v[12:27]
    v_mfma_f32_32x32x16_bf16 v[28:43], v[56:59], v[88:91], v[28:43]
    s_cmp_lg_u32 s93, 0
    s_cbranch_scc1 L_nokv
    s_cmp_eq_u32 s70, 7
    s_cbranch_scc1 L_nokv
    s_cmp_lg_u32 s70, 6
    s_cbranch_scc1 L_kvpub
    s_nop 4
    v_cvt_pk_bf16_f32 v232, v24, v24
    v_and_b32 v232, s92, v232
    v_mul_f32 v232, 0xbfb8aa3b, v232
    v_exp_f32 v232, v232
    s_nop 0
    v_add_f32 v232, 1.0, v232
    v_rcp_f32 v232, v232
    s_nop 0
    v_cvt_pk_bf16_f32 v232, v232, v232
    v_and_b32 v232, s92, v232
    v_sub_f32 v233, 1.0, v232
    v_cvt_pk_bf16_f32 v233, v233, v233
    v_and_b32 v233, s92, v233
    v_cvt_pk_bf16_f32 v234, v40, v40
    v_and_b32 v234, s92, v234
    v_mul_f32 v234, 0xbfb8aa3b, v234
    v_exp_f32 v234, v234
    s_nop 0
    v_add_f32 v234, 1.0, v234
    v_rcp_f32 v234, v234
    s_nop 0
    v_cvt_pk_bf16_f32 v234, v234, v234
    v_and_b32 v234, s92, v234
    v_sub_f32 v235, 1.0, v234
    v_cvt_pk_bf16_f32 v235, v235, v235
    v_and_b32 v235, s92, v235
    v_lshlrev_b32 v5, 3, v2
    s_lshl_b32 s72, s69, 9
    s_add_u32 s72, s72, 0x7b0000
    s_mov_b32 exec_hi, 0
    buffer_store_dwordx2 v[232:233], v5, s[8:11], s72 offen offset:0 sc1
    buffer_store_dwordx2 v[234:235], v5, s[8:11], s72 offen offset:256 sc1
    s_mov_b32 exec_hi, -1
    s_mov_b32 s87, 2
    v_mov_b32 v241, 0
    v_mov_b32 v243, 0
    s_branch L_nokv
L_kvpub:
    s_lshl_b32 s77, s69, 1
    s_mul_i32 s78, s77, 2560
    s_add_u32 s78, s78, 0xcb0000
    s_mov_b32 s87, 2
    s_nop 0
    v_cvt_pk_bf16_f32 v232, v24, v25
    v_cvt_pk_bf16_f32 v233, v26, v27
    v_mov_b32 v241, 0
    v_cvt_pk_bf16_f32 v234, v40, v41
    v_cvt_pk_bf16_f32 v235, v42, v43
    v_mov_b32 v243, 0
    s_cmp_ge_u32 s70, 3
    s_cbranch_scc1 L_vpub
    s_lshl_b32 s72, s70, 9
    v_lshl_add_u32 v6, v2, 4, s72
    v_lshl_add_u32 v6, v3, 3, v6
    s_cmp_lg_u32 s70, 2
    s_cbranch_scc1 L_kst
    v_lshlrev_b32 v6, 4, v2
    s_mov_b64 exec, s[88:89]
L_kst:
    v_lshlrev_b32 v24, 16, v232
    v_and_b32 v25, s92, v232
    v_lshlrev_b32 v26, 16, v233
    v_and_b32 v27, s92, v233
    v_mul_f32 v24, 0x3ea52b0c, v24
    v_mul_f32 v25, 0x3ea52b0c, v25
    v_mul_f32 v26, 0x3ea52b0c, v26
    v_mul_f32 v27, 0x3ea52b0c, v27
    v_cvt_pk_bf16_f32 v232, v24, v25
    v_cvt_pk_bf16_f32 v233, v26, v27
    v_lshlrev_b32 v40, 16, v234
    v_and_b32 v41, s92, v234
    v_lshlrev_b32 v42, 16, v235
    v_and_b32 v43, s92, v235
    v_mul_f32 v40, 0x3ea52b0c, v40
    v_mul_f32 v41, 0x3ea52b0c, v41
    v_mul_f32 v42, 0x3ea52b0c, v42
    v_mul_f32 v43, 0x3ea52b0c, v43
    v_cvt_pk_bf16_f32 v234, v40, v41
    v_cvt_pk_bf16_f32 v235, v42, v43
    s_cmp_eq_u32 s70, 2
    s_cbranch_scc1 L_k2st
    buffer_store_dwordx2 v[232:233], v6, s[8:11], s78 offen offset:0 sc1
    buffer_store_dwordx2 v[234:235], v6, s[8:11], s78 offen offset:1024 sc1
    s_branch L_k2e
L_k2st:
    buffer_store_dwordx4 v[232:235], v6, s[8:11], s78 offen offset:2048 sc1
L_k2e:
    v_fmac_f32 v241, v24, v24
    v_fmac_f32 v241, v25, v25
    v_fmac_f32 v241, v26, v26
    v_fmac_f32 v241, v27, v27
    v_fmac_f32 v243, v40, v40
    v_fmac_f32 v243, v41, v41
    v_fmac_f32 v243, v42, v42
    v_fmac_f32 v243, v43, v43
    s_mov_b64 exec, -1
    s_branch L_nokv
L_vpub:
    v_lshlrev_b32 v5, 4, v2
    v_lshl_add_u32 v5, v3, 3, v5
    v_add_u32 v5, 152576, v5
    ds_write_b64 v5, v[232:233] offset:0
    ds_write_b64 v5, v[234:235] offset:512
    v_lshrrev_b32 v6, 4, v1
    v_lshlrev_b32 v5, 7, v6
    v_bfe_u32 v7, v1, 1, 1
    v_lshl_add_u32 v5, v7, 6, v5
    v_bfe_u32 v7, v1, 2, 2
    v_lshl_add_u32 v5, v7, 4, v5
    v_and_b32 v7, 1, v1
    v_lshl_add_u32 v5, v7, 3, v5
    v_add_u32 v5, 152576, v5
    ds_read_b64_tr_b16 v[232:233], v5 offset:0
    ds_read_b64_tr_b16 v[234:235], v5 offset:512
    s_cmp_eq_u32 s70, 5
    s_cselect_b32 s72, 6, 7
    s_cselect_b32 s73, 3, 7
    s_cselect_b32 s90, 0xf0f0f0f0, -1
    v_lshlrev_b32 v7, s72, v6
    v_and_b32 v5, s73, v1
    v_lshl_add_u32 v7, v5, 4, v7
    v_bfe_u32 v6, v1, 3, 1
    v_lshl_add_u32 v7, v6, 3, v7
    s_lshl_b32 s72, s70, 9
    s_add_u32 s78, s78, s72
    s_add_u32 s78, s78, 1024
    s_mov_b32 exec_lo, s90
    s_mov_b32 exec_hi, s90
    s_waitcnt lgkmcnt(0)
    buffer_store_dwordx2 v[232:233], v7, s[8:11], s78 offen offset:0 sc1
    buffer_store_dwordx2 v[234:235], v7, s[8:11], s78 offen offset:1280 sc1
    s_mov_b64 exec, -1
L_nokv:
    v_lshlrev_b32 v239, 3, v1
    s_cmp_lt_u32 s87, 2
    s_cbranch_scc1 L_nokn
    v_permlane32_swap_b32 v241, v243
    v_add_f32 v241, v241, v243
    s_nop 1
    v_max_f32_dpp v241, v241, v241 row_ror:8 row_mask:0xf bank_mask:0xf
    s_nop 1
    v_max_f32_dpp v241, v241, v241 row_ror:4 row_mask:0xf bank_mask:0xf
    s_nop 1
    v_max_f32_dpp v241, v241, v241 row_ror:2 row_mask:0xf bank_mask:0xf
    s_nop 1
    v_max_f32_dpp v241, v241, v241 row_ror:1 row_mask:0xf bank_mask:0xf
    v_mov_b32 v8, v241
    s_nop 1
    v_permlane16_swap_b32 v241, v8
    v_max_f32 v241, v241, v8
    v_mov_b32 v8, v241
    s_nop 1
    v_permlane32_swap_b32 v241, v8
    v_max_f32 v241, v241, v8
    v_mov_b32 v240, s71
    s_lshl_b32 s77, s69, 3
    s_add_u32 s77, s77, s70
    s_lshl_b32 s77, s77, 7
    s_add_u32 s77, s77, 0xd04000
L_nokn:
    s_nop 5
    v_cvt_pk_bf16_f32 v216, v12, v13
    v_cvt_pk_bf16_f32 v217, v14, v15
    v_cvt_pk_bf16_f32 v218, v16, v17
    v_cvt_pk_bf16_f32 v219, v18, v19
    v_cvt_pk_bf16_f32 v220, v20, v21
    v_cvt_pk_bf16_f32 v221, v22, v23
    v_cvt_pk_bf16_f32 v224, v28, v29
    v_cvt_pk_bf16_f32 v225, v30, v31
    v_cvt_pk_bf16_f32 v226, v32, v33
    v_cvt_pk_bf16_f32 v227, v34, v35
    v_cvt_pk_bf16_f32 v228, v36, v37
    v_cvt_pk_bf16_f32 v229, v38, v39
    v_permlane32_swap_b32 v216, v218
    v_permlane32_swap_b32 v217, v219
    v_permlane32_swap_b32 v224, v226
    v_permlane32_swap_b32 v225, v227
    s_mov_b64 exec, s[88:89]
    v_mov_b32 v220, 0
    v_mov_b32 v221, 0
    v_mov_b32 v228, 0
    v_mov_b32 v229, 0
    s_mov_b64 exec, -1
    v_mov_b32 v222, 0
    v_mov_b32 v230, 0
    v_dot2_f32_bf16 v222, v216, v216, v222
    v_dot2_f32_bf16 v230, v224, v224, v230
    v_dot2_f32_bf16 v222, v217, v217, v222
    v_dot2_f32_bf16 v230, v225, v225, v230
    v_dot2_f32_bf16 v222, v218, v218, v222
    v_dot2_f32_bf16 v230, v226, v226, v230
    v_dot2_f32_bf16 v222, v219, v219, v222
    v_dot2_f32_bf16 v230, v227, v227, v230
    v_dot2_f32_bf16 v222, v220, v220, v222
    v_dot2_f32_bf16 v230, v228, v228, v230
    v_dot2_f32_bf16 v222, v221, v221, v222
    v_dot2_f32_bf16 v230, v229, v229, v230
    s_nop 1
    v_mov_b32 v223, v222
    v_mov_b32 v231, v230
    s_nop 0
    v_permlane32_swap_b32 v222, v223
    v_permlane32_swap_b32 v230, v231
    s_mov_b64 exec, s[88:89]
    v_add_f32 v220, v222, v223
    v_add_f32 v228, v230, v231
    s_mov_b64 exec, -1
    v_mov_b32 v8, 153856
    s_mov_b32 s75, 3000000
L_hq:
    ds_read_b128 v[44:47], v8 offset:16
    s_sub_u32 s75, s75, 1
    s_cmp_eq_u32 s75, 0
    s_cbranch_scc1 L_end
    s_waitcnt lgkmcnt(0)
    v_min_u32 v44, v44, v45
    v_min3_u32 v44, v44, v46, v47
    s_nop 0
    v_readfirstlane_b32 s74, v44
    s_nop 0
    s_cmp_ge_u32 s74, 10
    s_cbranch_scc1 L_hq_ok
    s_sleep 1
    s_branch L_hq
L_hq_ok:
    s_mul_i32 s72, s93, 3072
    s_add_u32 s72, s72, 20480
    v_add_u32 v5, s72, v4
    v_lshl_add_u32 v6, v1, 3, s72
    ds_write_b128 v5, v[216:219] offset:0
    ds_write_b64 v6, v[220:221] offset:1024
    ds_write_b128 v5, v[224:227] offset:1536
    ds_write_b64 v6, v[228:229] offset:2560
    ds_write_b32 v113, v115 offset:48
    s_cmp_lt_u32 s87, 2
    s_cbranch_scc1 L_nf
    s_waitcnt vmcnt(0)
    s_mov_b64 exec, 0xffff
    buffer_store_dwordx2 v[240:241], v239, s[8:11], s77 offen sc1
    s_mov_b64 exec, -1
L_nf:
    s_setprio 0
L_join:
    s_bitcmp1_b32 s2, 0
    s_mov_b32 s72, 0xa6951840
    s_cselect_b32 s72, 0xca629510, s72
    s_lshl_b32 s73, s68, 2
    s_lshr_b32 s72, s72, s73
    s_and_b32 s86, s72, 3
    s_bfe_u32 s85, s72, 0x20002
    s_add_u32 s84, s6, s86
    s_mul_i32 s72, s86, 16896
    s_cmp_eq_u32 s85, 2
    s_cselect_b32 s73, 0, 2048
    s_add_u32 s72, s72, s73
    s_add_u32 s72, s72, 78912
    v_and_b32 v6, 3, v2
    v_mul_u32_u24 v212, 4160, v6
    v_lshl_add_u32 v212, v3, 4, v212
    v_lshrrev_b32 v5, 2, v2
    v_lshlrev_b32 v5, 3, v5
    v_sub_u32 v212, v212, v5
    v_add_u32 v212, s72, v212
    s_mul_i32 s72, s86, 7680
    s_add_u32 s72, s72, 129536
    s_cmp_eq_u32 s85, 1
    s_cselect_b32 s73, 2560, 0
    s_add_u32 s72, s72, s73
    v_mul_u32_u24 v213, 80, v2
    v_lshl_add_u32 v213, v3, 4, v213
    v_add_u32 v213, s72, v213
    v_lshlrev_b32 v248, 3, v1
    v_mov_b32 v94, v213
    v_mov_b32 v95, 129536
    s_mov_b32 exec_lo, 0xffff
    s_mov_b32 exec_hi, 0xffff
    v_add_u32 v94, 1312, v213
    v_add_u32 v95, 992, v212
    s_mov_b64 exec, -1
    v_mov_b32 v8, 153856
    s_mov_b32 s75, 3000000
L_hc:
    ds_read_b128 v[44:47], v8 offset:32
    s_sub_u32 s75, s75, 1
    s_cmp_eq_u32 s75, 0
    s_cbranch_scc1 L_end
    s_waitcnt lgkmcnt(0)
    v_min_u32 v44, v44, v45
    v_min3_u32 v44, v44, v46, v47
    s_nop 0
    v_readfirstlane_b32 s74, v44
    s_nop 0
    s_cmp_ge_u32 s74, 10
    s_cbranch_scc1 L_hc_ok
    s_sleep 1
    s_branch L_hc
L_hc_ok:
    s_cmp_lg_u32 s85, 1
    s_cbranch_scc1 L_tri
    ds_read_b64 v[28:29], v212 offset:0
    ds_read_b64 v[30:31], v212 offset:8
    ds_read_b128 v[36:39], v213 offset:0
    ds_read_b64 v[32:33], v212 offset:32
    ds_read_b64 v[34:35], v212 offset:40
    ds_read_b128 v[40:43], v213 offset:32
    ds_read_b64 v[12:13], v212 offset:64
    ds_read_b64 v[14:15], v212 offset:72
    ds_read_b128 v[20:23], v213 offset:80
    ds_read_b64 v[16:17], v212 offset:96
    ds_read_b64 v[18:19], v212 offset:104
    ds_read_b128 v[24:27], v213 offset:112
    s_waitcnt lgkmcnt(9)
    v_mfma_f32_32x32x16_bf16 v[232:247], v[28:31], v[36:39], 0
    ds_read_b64 v[28:29], v212 offset:128
    ds_read_b64 v[30:31], v212 offset:136
    ds_read_b128 v[36:39], v213 offset:160
    v_mov_b32 v209, 0
    s_lshl_b32 s72, s68, 12
    s_add_u32 s72, s72, 0xd04000
    v_lshl_add_u32 v214, v2, 7, s72
    v_lshl_add_u32 v214, v3, 14, v214
    s_mul_i32 s72, s68, 1536
    s_waitcnt lgkmcnt(9)
    v_mfma_f32_32x32x16_bf16 v[232:247], v[32:35], v[40:43], v[232:247]
    ds_read_b64 v[32:33], v212 offset:160
    ds_read_b64 v[34:35], v212 offset:168
    ds_read_b128 v[40:43], v213 offset:192
    s_add_u32 s72, s72, 20480
    v_mov_b32 v76, 153856
    v_add_u32 v77, s72, v4
    v_add_u32 v78, s72, v248
    v_lshl_add_u32 v79, v2, 3, s72
    s_mov_b32 s94, 0x7f7f7f7f
    s_waitcnt lgkmcnt(9)
    v_mfma_f32_32x32x16_bf16 v[232:247], v[12:15], v[20:23], v[232:247]
    ds_read_b64 v[12:13], v212 offset:192
    ds_read_b64 v[14:15], v212 offset:200
    ds_read_b128 v[20:23], v213 offset:240
    s_mov_b32 s95, 0x7f7f7f7f
    v_lshrrev_b32 v5, 3, v2
    v_lshrrev_b32 v6, 4, v2
    v_sub_u32 v6, 7, v6
    v_lshlrev_b32 v249, v6, v3
    v_lshl_add_u32 v249, v5, 9, v249
    s_waitcnt lgkmcnt(9)
    v_mfma_f32_32x32x16_bf16 v[232:247], v[16:19], v[24:27], v[232:247]
    ds_read_b64 v[16:17], v212 offset:224
    ds_read_b64 v[18:19], v212 offset:232
    ds_read_b128 v[24:27], v213 offset:272
    v_and_b32 v5, 7, v2
    v_lshl_add_u32 v249, v5, 4, v249
    v_lshl_add_u32 v250, 2, v6, v249
    s_mul_i32 s79, s68, 20480
    s_add_u32 s79, s79, 0xcb0000
    s_bfe_u32 s80, s2, 0x20003
    s_waitcnt lgkmcnt(9)
    v_mfma_f32_32x32x16_bf16 v[232:247], v[28:31], v[36:39], v[232:247]
    ds_read_b64 v[28:29], v212 offset:256
    ds_read_b64 v[30:31], v212 offset:264
    ds_read_b128 v[36:39], v213 offset:320
    v_add_u32 v80, s80, v3
    v_add_u32 v81, 2, v80
    v_and_b32 v80, 3, v80
    v_mul_u32_u24 v80, 5120, v80
    v_lshl_add_u32 v80, v2, 4, v80
    v_and_b32 v81, 3, v81
    s_waitcnt lgkmcnt(9)
    v_mfma_f32_32x32x16_bf16 v[232:247], v[32:35], v[40:43], v[232:247]
    ds_read_b64 v[32:33], v212 offset:288
    ds_read_b64 v[34:35], v212 offset:296
    ds_read_b128 v[40:43], v213 offset:352
    v_mul_u32_u24 v81, 5120, v81
    v_lshl_add_u32 v81, v2, 4, v81
    s_mov_b32 s90, 0x000fffff
    s_mov_b32 s91, 0x000fffff
    s_mov_b32 s16, s58
    s_and_b32 s17, s59, 0xffff
    s_waitcnt lgkmcnt(9)
    v_mfma_f32_32x32x16_bf16 v[232:247], v[12:15], v[20:23], v[232:247]
    ds_read_b64 v[12:13], v212 offset:320
    ds_read_b64 v[14:15], v212 offset:328
    ds_read_b128 v[20:23], v213 offset:400
    s_mov_b32 s18, 0xc8000
    s_mov_b32 s19, 0x00020000
    s_lshr_b32 s72, s2, 3
    s_lshl_b32 s72, s72, 3
    s_add_u32 s72, s72, s68
    s_mul_i32 s72, s72, 3200
    s_waitcnt lgkmcnt(9)
    v_mfma_f32_32x32x16_bf16 v[232:247], v[16:19], v[24:27], v[232:247]
    ds_read_b64 v[16:17], v212 offset:352
    ds_read_b64 v[18:19], v212 offset:360
    ds_read_b128 v[24:27], v213 offset:432
    v_min_u32 v7, 24, v1
    v_lshlrev_b32 v7, 7, v7
    buffer_load_dword v215, v7, s[16:19], s72 offen
    v_mov_b32 v44, 0
    v_mov_b32 v45, 0
    v_mov_b32 v46, 0
    s_waitcnt lgkmcnt(9)
    v_mfma_f32_32x32x16_bf16 v[232:247], v[28:31], v[36:39], v[232:247]
    ds_read_b64 v[28:29], v212 offset:384
    ds_read_b64 v[30:31], v212 offset:392
    ds_read_b128 v[36:39], v213 offset:480
    v_mov_b32 v47, 0
    v_mov_b32 v48, 0
    v_mov_b32 v49, 0
    v_mov_b32 v50, 0
    v_mov_b32 v51, 0
    v_mov_b32 v52, 0
    s_setprio 1
    s_waitcnt lgkmcnt(9)
    v_mfma_f32_32x32x16_bf16 v[232:247], v[32:35], v[40:43], v[232:247]
    ds_read_b64 v[32:33], v212 offset:416
    ds_read_b64 v[34:35], v212 offset:424
    ds_read_b128 v[40:43], v213 offset:512
    v_mov_b32 v53, 0
    v_mov_b32 v54, 0
    v_mov_b32 v55, 0
    v_mov_b32 v56, 0
    v_mov_b32 v57, 0
    v_mov_b32 v58, 0
    s_waitcnt lgkmcnt(9)
    v_mfma_f32_32x32x16_bf16 v[232:247], v[12:15], v[20:23], v[232:247]
    ds_read_b64 v[12:13], v212 offset:448
    ds_read_b64 v[14:15], v212 offset:456
    ds_read_b128 v[20:23], v213 offset:560
    v_mov_b32 v59, 0
    v_mov_b32 v60, 0
    v_mov_b32 v61, 0
    v_mov_b32 v62, 0
    v_mov_b32 v63, 0
    v_mov_b32 v64, 0
    s_waitcnt lgkmcnt(9)
    v_mfma_f32_32x32x16_bf16 v[232:247], v[16:19], v[24:27], v[232:247]
    ds_read_b64 v[16:17], v212 offset:480
    ds_read_b64 v[18:19], v212 offset:488
    ds_read_b128 v[24:27], v213 offset:592
    v_mov_b32 v65, 0
    v_mov_b32 v66, 0
    v_mov_b32 v67, 0
    v_mov_b32 v68, 0
    v_mov_b32 v69, 0
    v_mov_b32 v70, 0
    s_waitcnt lgkmcnt(9)
    v_mfma_f32_32x32x16_bf16 v[232:247], v[28:31], v[36:39], v[232:247]
    ds_read_b64 v[28:29], v212 offset:512
    ds_read_b64 v[30:31], v212 offset:520
    ds_read_b128 v[36:39], v213 offset:640
    v_mov_b32 v71, 0
    v_mov_b32 v72, 0
    v_mov_b32 v73, 0
    v_mov_b32 v74, 0
    v_mov_b32 v75, 0
    v_lshlrev_b32 v7, 6, v2
    s_waitcnt lgkmcnt(9)
    v_mfma_f32_32x32x16_bf16 v[232:247], v[32:35], v[40:43], v[232:247]
    ds_read_b64 v[32:33], v212 offset:544
    ds_read_b64 v[34:35], v212 offset:552
    ds_read_b128 v[40:43], v213 offset:672
    v_lshl_add_u32 v7, v3, 4, v7
    s_cmp_ge_u32 s85, 2
    s_cselect_b32 s74, 0x80000000, 0
    v_or_b32 v9, s74, v7
    s_mul_i32 s72, s84, 4224
    s_and_b32 s73, s85, 1
    s_waitcnt lgkmcnt(9)
    v_mfma_f32_32x32x16_bf16 v[232:247], v[12:15], v[20:23], v[232:247]
    ds_read_b64 v[12:13], v212 offset:576
    ds_read_b64 v[14:15], v212 offset:584
    ds_read_b128 v[20:23], v213 offset:720
    s_lshl_b32 s73, s73, 11
    s_add_u32 s72, s72, s73
    s_add_u32 s82, s72, 0x800000
    s_add_u32 s38, s68, 1
    s_and_b32 s38, s38, 7
    s_mul_i32 s38, s38, 1536
    s_waitcnt lgkmcnt(9)
    v_mfma_f32_32x32x16_bf16 v[232:247], v[16:19], v[24:27], v[232:247]
    ds_read_b64 v[16:17], v212 offset:608
    ds_read_b64 v[18:19], v212 offset:616
    ds_read_b128 v[24:27], v213 offset:752
    s_add_u32 s50, s68, 2
    s_and_b32 s50, s50, 7
    s_mul_i32 s50, s50, 3072
    s_add_u32 s39, s68, 2
    s_and_b32 s39, s39, 7
    s_mul_i32 s39, s39, 1536
    s_waitcnt lgkmcnt(9)
    v_mfma_f32_32x32x16_bf16 v[232:247], v[28:31], v[36:39], v[232:247]
    ds_read_b64 v[28:29], v212 offset:640
    ds_read_b64 v[30:31], v212 offset:648
    ds_read_b128 v[36:39], v213 offset:800
    s_add_u32 s51, s68, 4
    s_and_b32 s51, s51, 7
    s_mul_i32 s51, s51, 3072
    s_add_u32 s40, s68, 3
    s_and_b32 s40, s40, 7
    s_mul_i32 s40, s40, 1536
    s_waitcnt lgkmcnt(9)
    v_mfma_f32_32x32x16_bf16 v[232:247], v[32:35], v[40:43], v[232:247]
    ds_read_b64 v[32:33], v212 offset:672
    ds_read_b64 v[34:35], v212 offset:680
    ds_read_b128 v[40:43], v213 offset:832
    s_add_u32 s52, s68, 6
    s_and_b32 s52, s52, 7
    s_mul_i32 s52, s52, 3072
    s_add_u32 s41, s68, 4
    s_and_b32 s41, s41, 7
    s_mul_i32 s41, s41, 1536
    s_waitcnt lgkmcnt(9)
    v_mfma_f32_32x32x16_bf16 v[232:247], v[12:15], v[20:23], v[232:247]
    ds_read_b64 v[12:13], v212 offset:704
    ds_read_b64 v[14:15], v212 offset:712
    ds_read_b128 v[20:23], v213 offset:880
    s_add_u32 s53, s68, 8
    s_and_b32 s53, s53, 7
    s_mul_i32 s53, s53, 3072
    s_add_u32 s42, s68, 5
    s_and_b32 s42, s42, 7
    s_mul_i32 s42, s42, 1536
    s_waitcnt lgkmcnt(9)
    v_mfma_f32_32x32x16_bf16 v[232:247], v[16:19], v[24:27], v[232:247]
    ds_read_b64 v[16:17], v212 offset:736
    ds_read_b64 v[18:19], v212 offset:744
    ds_read_b128 v[24:27], v213 offset:912
    s_mov_b32 s54, s50
    s_add_u32 s43, s68, 6
    s_and_b32 s43, s43, 7
    s_mul_i32 s43, s43, 1536
    s_mov_b32 s55, s51
    s_add_u32 s44, s68, 7
    s_waitcnt lgkmcnt(9)
    v_mfma_f32_32x32x16_bf16 v[232:247], v[28:31], v[36:39], v[232:247]
    ds_read_b64 v[28:29], v212 offset:768
    ds_read_b64 v[30:31], v212 offset:776
    ds_read_b128 v[36:39], v213 offset:960
    s_and_b32 s44, s44, 7
    s_mul_i32 s44, s44, 1536
    s_mov_b32 s56, s52
    s_add_u32 s57, s68, 15
    s_and_b32 s57, s57, 7
    s_mul_i32 s57, s57, 3072
    s_waitcnt lgkmcnt(9)
    v_mfma_f32_32x32x16_bf16 v[232:247], v[32:35], v[40:43], v[232:247]
    ds_read_b64 v[32:33], v212 offset:800
    ds_read_b64 v[34:35], v212 offset:808
    ds_read_b128 v[40:43], v213 offset:992
    s_waitcnt lgkmcnt(9)
    v_mfma_f32_32x32x16_bf16 v[232:247], v[12:15], v[20:23], v[232:247]
    ds_read_b64 v[12:13], v212 offset:832
    ds_read_b64 v[14:15], v212 offset:840
    ds_read_b128 v[20:23], v213 offset:1040
    s_waitcnt lgkmcnt(9)
    v_mfma_f32_32x32x16_bf16 v[232:247], v[16:19], v[24:27], v[232:247]
    ds_read_b64 v[16:17], v212 offset:864
    ds_read_b64 v[18:19], v212 offset:872
    ds_read_b128 v[24:27], v213 offset:1072
    s_waitcnt lgkmcnt(9)
    v_mfma_f32_32x32x16_bf16 v[232:247], v[28:31], v[36:39], v[232:247]
    ds_read_b64 v[28:29], v212 offset:896
    ds_read_b64 v[30:31], v212 offset:904
    ds_read_b128 v[36:39], v213 offset:1120
    s_waitcnt lgkmcnt(9)
    v_mfma_f32_32x32x16_bf16 v[232:247], v[32:35], v[40:43], v[232:247]
    ds_read_b64 v[32:33], v212 offset:928
    ds_read_b64 v[34:35], v212 offset:936
    ds_read_b128 v[40:43], v213 offset:1152
    s_waitcnt lgkmcnt(9)
    v_mfma_f32_32x32x16_bf16 v[232:247], v[12:15], v[20:23], v[232:247]
    ds_read_b64 v[12:13], v212 offset:960
    ds_read_b64 v[14:15], v212 offset:968
    ds_read_b128 v[20:23], v213 offset:1200
    s_waitcnt lgkmcnt(9)
    v_mfma_f32_32x32x16_bf16 v[232:247], v[16:19], v[24:27], v[232:247]
    ds_read_b64 v[16:17], v212 offset:992
    ds_read_b64 v[18:19], v212 offset:1000
    ds_read_b128 v[24:27], v213 offset:1232
    s_waitcnt lgkmcnt(9)
    v_mfma_f32_32x32x16_bf16 v[232:247], v[28:31], v[36:39], v[232:247]
    ds_read_b64 v[28:29], v212 offset:1024
    ds_read_b64 v[30:31], v212 offset:1032
    ds_read_b128 v[36:39], v213 offset:1280
    s_waitcnt lgkmcnt(9)
    v_mfma_f32_32x32x16_bf16 v[232:247], v[32:35], v[40:43], v[232:247]
    ds_read_b64 v[32:33], v212 offset:1056
    ds_read_b64 v[34:35], v212 offset:1064
    ds_read_b128 v[40:43], v213 offset:1312
    s_waitcnt lgkmcnt(9)
    v_mfma_f32_32x32x16_bf16 v[232:247], v[12:15], v[20:23], v[232:247]
    ds_read_b64 v[12:13], v212 offset:1088
    ds_read_b64 v[14:15], v212 offset:1096
    ds_read_b128 v[20:23], v213 offset:1360
    s_waitcnt lgkmcnt(9)
    v_mfma_f32_32x32x16_bf16 v[232:247], v[16:19], v[24:27], v[232:247]
    ds_read_b64 v[16:17], v212 offset:1120
    ds_read_b64 v[18:19], v212 offset:1128
    ds_read_b128 v[24:27], v213 offset:1392
    s_waitcnt lgkmcnt(9)
    v_mfma_f32_32x32x16_bf16 v[232:247], v[28:31], v[36:39], v[232:247]
    ds_read_b64 v[28:29], v212 offset:1152
    ds_read_b64 v[30:31], v212 offset:1160
    ds_read_b128 v[36:39], v213 offset:1440
    s_waitcnt lgkmcnt(9)
    v_mfma_f32_32x32x16_bf16 v[232:247], v[32:35], v[40:43], v[232:247]
    ds_read_b64 v[32:33], v212 offset:1184
    ds_read_b64 v[34:35], v212 offset:1192
    ds_read_b128 v[40:43], v213 offset:1472
    s_waitcnt lgkmcnt(9)
    v_mfma_f32_32x32x16_bf16 v[232:247], v[12:15], v[20:23], v[232:247]
    ds_read_b64 v[12:13], v212 offset:1216
    ds_read_b64 v[14:15], v212 offset:1224
    ds_read_b128 v[20:23], v213 offset:1520
    s_waitcnt lgkmcnt(9)
    v_mfma_f32_32x32x16_bf16 v[232:247], v[16:19], v[24:27], v[232:247]
    ds_read_b64 v[16:17], v212 offset:1248
    ds_read_b64 v[18:19], v212 offset:1256
    ds_read_b128 v[24:27], v213 offset:1552
    s_waitcnt lgkmcnt(9)
    v_mfma_f32_32x32x16_bf16 v[232:247], v[28:31], v[36:39], v[232:247]
    ds_read_b64 v[28:29], v212 offset:1280
    ds_read_b64 v[30:31], v212 offset:1288
    ds_read_b128 v[36:39], v213 offset:1600
    s_waitcnt lgkmcnt(9)
    v_mfma_f32_32x32x16_bf16 v[232:247], v[32:35], v[40:43], v[232:247]
    ds_read_b64 v[32:33], v212 offset:1312
    ds_read_b64 v[34:35], v212 offset:1320
    ds_read_b128 v[40:43], v213 offset:1632
    s_waitcnt lgkmcnt(9)
    v_mfma_f32_32x32x16_bf16 v[232:247], v[12:15], v[20:23], v[232:247]
    ds_read_b64 v[12:13], v212 offset:1344
    ds_read_b64 v[14:15], v212 offset:1352
    ds_read_b128 v[20:23], v213 offset:1680
    s_waitcnt lgkmcnt(9)
    v_mfma_f32_32x32x16_bf16 v[232:247], v[16:19], v[24:27], v[232:247]
    ds_read_b64 v[16:17], v212 offset:1376
    ds_read_b64 v[18:19], v212 offset:1384
    ds_read_b128 v[24:27], v213 offset:1712
    s_waitcnt lgkmcnt(9)
    v_mfma_f32_32x32x16_bf16 v[232:247], v[28:31], v[36:39], v[232:247]
    ds_read_b64 v[28:29], v212 offset:1408
    ds_read_b64 v[30:31], v212 offset:1416
    ds_read_b128 v[36:39], v213 offset:1760
    s_waitcnt lgkmcnt(9)
    v_mfma_f32_32x32x16_bf16 v[232:247], v[32:35], v[40:43], v[232:247]
    ds_read_b64 v[32:33], v212 offset:1440
    ds_read_b64 v[34:35], v212 offset:1448
    ds_read_b128 v[40:43], v213 offset:1792
    s_waitcnt lgkmcnt(9)
    v_mfma_f32_32x32x16_bf16 v[232:247], v[12:15], v[20:23], v[232:247]
    ds_read_b64 v[12:13], v212 offset:1472
    ds_read_b64 v[14:15], v212 offset:1480
    ds_read_b128 v[20:23], v213 offset:1840
    s_waitcnt lgkmcnt(9)
    v_mfma_f32_32x32x16_bf16 v[232:247], v[16:19], v[24:27], v[232:247]
    ds_read_b64 v[16:17], v212 offset:1504
    ds_read_b64 v[18:19], v212 offset:1512
    ds_read_b128 v[24:27], v213 offset:1872
    s_waitcnt lgkmcnt(9)
    v_mfma_f32_32x32x16_bf16 v[232:247], v[28:31], v[36:39], v[232:247]
    ds_read_b64 v[28:29], v212 offset:1536
    ds_read_b64 v[30:31], v212 offset:1544
    ds_read_b128 v[36:39], v213 offset:1920
    s_waitcnt lgkmcnt(9)
    v_mfma_f32_32x32x16_bf16 v[232:247], v[32:35], v[40:43], v[232:247]
    ds_read_b64 v[32:33], v212 offset:1568
    ds_read_b64 v[34:35], v212 offset:1576
    ds_read_b128 v[40:43], v213 offset:1952
    s_cmp_lt_u32 s68, 4
    s_cbranch_scc1 L_cpf
L_cpf_e:
    s_waitcnt lgkmcnt(9)
    v_mfma_f32_32x32x16_bf16 v[232:247], v[12:15], v[20:23], v[232:247]
    ds_read_b64 v[12:13], v212 offset:1600
    ds_read_b64 v[14:15], v212 offset:1608
    ds_read_b128 v[20:23], v213 offset:2000
    s_waitcnt lgkmcnt(9)
    v_mfma_f32_32x32x16_bf16 v[232:247], v[16:19], v[24:27], v[232:247]
    ds_read_b64 v[16:17], v212 offset:1632
    ds_read_b64 v[18:19], v212 offset:1640
    ds_read_b128 v[24:27], v213 offset:2032
    s_waitcnt lgkmcnt(9)
    v_mfma_f32_32x32x16_bf16 v[232:247], v[28:31], v[36:39], v[232:247]
    ds_read_b64 v[28:29], v212 offset:1664
    ds_read_b64 v[30:31], v212 offset:1672
    ds_read_b128 v[36:39], v213 offset:2080
    s_waitcnt lgkmcnt(9)
    v_mfma_f32_32x32x16_bf16 v[232:247], v[32:35], v[40:43], v[232:247]
    ds_read_b64 v[32:33], v212 offset:1696
    ds_read_b64 v[34:35], v212 offset:1704
    ds_read_b128 v[40:43], v213 offset:2112
    s_waitcnt lgkmcnt(9)
    v_mfma_f32_32x32x16_bf16 v[232:247], v[12:15], v[20:23], v[232:247]
    ds_read_b64 v[12:13], v212 offset:1728
    ds_read_b64 v[14:15], v212 offset:1736
    ds_read_b128 v[20:23], v213 offset:2160
    ds_read_b128 v[120:123], v76 offset:48
    ds_read_b128 v[124:127], v76 offset:64
    ds_read_b128 v[84:87], v77
    ds_read_b64 v[92:93], v78 offset:1024
    ds_read_b32 v210, v79 offset:1280
    s_waitcnt lgkmcnt(9)
    v_mfma_f32_32x32x16_bf16 v[232:247], v[16:19], v[24:27], v[232:247]
    ds_read_b64 v[16:17], v212 offset:1760
    ds_read_b64 v[18:19], v212 offset:1768
    ds_read_b128 v[24:27], v213 offset:2192
    s_waitcnt lgkmcnt(9)
    v_mfma_f32_32x32x16_bf16 v[232:247], v[28:31], v[36:39], v[232:247]
    ds_read_b64 v[28:29], v212 offset:1792
    ds_read_b64 v[30:31], v212 offset:1800
    ds_read_b128 v[36:39], v213 offset:2240
    s_waitcnt lgkmcnt(9)
    v_mfma_f32_32x32x16_bf16 v[232:247], v[32:35], v[40:43], v[232:247]
    ds_read_b64 v[32:33], v212 offset:1824
    ds_read_b64 v[34:35], v212 offset:1832
    ds_read_b128 v[40:43], v213 offset:2272
    s_waitcnt lgkmcnt(9)
    v_mfma_f32_32x32x16_bf16 v[232:247], v[12:15], v[20:23], v[232:247]
    ds_read_b64 v[12:13], v212 offset:1856
    ds_read_b64 v[14:15], v212 offset:1864
    ds_read_b128 v[20:23], v213 offset:2320
    v_min_u32 v5, v120, v121
    v_min3_u32 v5, v5, v122, v123
    v_min3_u32 v5, v5, v124, v125
    v_min3_u32 v5, v5, v126, v127
    s_waitcnt lgkmcnt(9)
    v_mfma_f32_32x32x16_bf16 v[232:247], v[16:19], v[24:27], v[232:247]
    ds_read_b64 v[16:17], v212 offset:1888
    ds_read_b64 v[18:19], v212 offset:1896
    ds_read_b128 v[24:27], v213 offset:2352
    v_max3_f32 v6, v120, v121, v122
    v_max_f32 v6, v6, v123
    v_mul_f32 v210, v210, v6
    v_sqrt_f32 v210, v210
    s_waitcnt lgkmcnt(9)
    v_mfma_f32_32x32x16_bf16 v[232:247], v[28:31], v[36:39], v[232:247]
    ds_read_b64 v[28:29], v212 offset:1920
    ds_read_b64 v[30:31], v212 offset:1928
    ds_read_b128 v[36:39], v213 offset:2400
    v_readfirstlane_b32 s87, v5
    v_mul_f32 v210, 0x3f83d70a, v210
    v_and_b32 v210, s92, v210
    v_cmp_lt_f32 vcc, 0x42400000, v210
    s_waitcnt lgkmcnt(9)
    v_mfma_f32_32x32x16_bf16 v[232:247], v[32:35], v[40:43], v[232:247]
    ds_read_b64 v[32:33], v212 offset:1952
    ds_read_b64 v[34:35], v212 offset:1960
    ds_read_b128 v[40:43], v213 offset:2432
    s_cmp_lg_u64 vcc, 0
    s_cselect_b32 s87, 0, s87
    s_mov_b64 exec, s[88:89]
    v_cvt_pk_bf16_f32 v92, -v210, 0
    s_mov_b64 exec, -1
    s_cmp_lg_u32 s87, 0
    s_cbranch_scc1 L_ckf
L_ckf_e:
    s_waitcnt lgkmcnt(9)
    v_mfma_f32_32x32x16_bf16 v[232:247], v[12:15], v[20:23], v[232:247]
    ds_read_b64 v[12:13], v212 offset:1984
    ds_read_b64 v[14:15], v212 offset:1992
    ds_read_b128 v[20:23], v213 offset:2480
    s_waitcnt lgkmcnt(9)
    v_mfma_f32_32x32x16_bf16 v[232:247], v[16:19], v[24:27], v[232:247]
    ds_read_b64 v[16:17], v212 offset:2016
    ds_read_b64 v[18:19], v212 offset:2024
    ds_read_b128 v[24:27], v213 offset:2512
    s_waitcnt lgkmcnt(9)
    v_mfma_f32_32x32x16_bf16 v[232:247], v[28:31], v[36:39], v[232:247]
    s_waitcnt lgkmcnt(6)
    v_mfma_f32_32x32x16_bf16 v[232:247], v[32:35], v[40:43], v[232:247]
    s_waitcnt lgkmcnt(3)
    v_mfma_f32_32x32x16_bf16 v[232:247], v[12:15], v[20:23], v[232:247]
    s_waitcnt lgkmcnt(0)
    v_mfma_f32_32x32x16_bf16 v[232:247], v[16:19], v[24:27], v[232:247]
    s_branch L_conv_end
L_tri:
    s_cmp_lg_u32 s85, 3
    s_cbranch_scc1 L_tri2
    v_mov_b32 v209, 0
    s_lshl_b32 s72, s68, 12
    s_add_u32 s72, s72, 0xd04000
    v_lshl_add_u32 v214, v2, 7, s72
    v_lshl_add_u32 v214, v3, 14, v214
    s_mul_i32 s72, s68, 1536
    s_add_u32 s72, s72, 20480
    v_mov_b32 v76, 153856
    v_add_u32 v77, s72, v4
    v_add_u32 v78, s72, v248
    v_lshl_add_u32 v79, v2, 3, s72
    s_mov_b32 s94, 0x7f7f7f7f
    s_mov_b32 s95, 0x7f7f7f7f
    v_lshrrev_b32 v5, 3, v2
    v_lshrrev_b32 v6, 4, v2
    v_sub_u32 v6, 7, v6
    v_lshlrev_b32 v249, v6, v3
    v_lshl_add_u32 v249, v5, 9, v249
    v_and_b32 v5, 7, v2
    v_lshl_add_u32 v249, v5, 4, v249
    v_lshl_add_u32 v250, 2, v6, v249
    s_mul_i32 s79, s68, 20480
    s_add_u32 s79, s79, 0xcb0000
    s_bfe_u32 s80, s2, 0x20003
    v_add_u32 v80, s80, v3
    v_add_u32 v81, 2, v80
    v_and_b32 v80, 3, v80
    v_mul_u32_u24 v80, 5120, v80
    v_lshl_add_u32 v80, v2, 4, v80
    v_and_b32 v81, 3, v81
    v_mul_u32_u24 v81, 5120, v81
    v_lshl_add_u32 v81, v2, 4, v81
    s_mov_b32 s90, 0x000fffff
    s_mov_b32 s91, 0x000fffff
    s_mov_b32 s16, s58
    s_and_b32 s17, s59, 0xffff
    s_mov_b32 s18, 0xc8000
    s_mov_b32 s19, 0x00020000
    s_lshr_b32 s72, s2, 3
    s_lshl_b32 s72, s72, 3
    s_add_u32 s72, s72, s68
    s_mul_i32 s72, s72, 3200
    v_min_u32 v7, 24, v1
    v_lshlrev_b32 v7, 7, v7
    buffer_load_dword v215, v7, s[16:19], s72 offen
    v_mov_b32 v44, 0
    v_mov_b32 v45, 0
    v_mov_b32 v46, 0
    v_mov_b32 v47, 0
    v_mov_b32 v48, 0
    v_mov_b32 v49, 0
    v_mov_b32 v50, 0
    v_mov_b32 v51, 0
    v_mov_b32 v52, 0
    v_mov_b32 v53, 0
    v_mov_b32 v54, 0
    v_mov_b32 v55, 0
    v_mov_b32 v56, 0
    v_mov_b32 v57, 0
    v_mov_b32 v58, 0
    v_mov_b32 v59, 0
    v_mov_b32 v60, 0
    v_mov_b32 v61, 0
    v_mov_b32 v62, 0
    v_mov_b32 v63, 0
    v_mov_b32 v64, 0
    v_mov_b32 v65, 0
    v_mov_b32 v66, 0
    v_mov_b32 v67, 0
    v_mov_b32 v68, 0
    v_mov_b32 v69, 0
    v_mov_b32 v70, 0
    v_mov_b32 v71, 0
    v_mov_b32 v72, 0
    v_mov_b32 v73, 0
    v_mov_b32 v74, 0
    v_mov_b32 v75, 0
    v_lshlrev_b32 v7, 6, v2
    v_lshl_add_u32 v7, v3, 4, v7
    s_cmp_ge_u32 s85, 2
    s_cselect_b32 s74, 0x80000000, 0
    v_or_b32 v9, s74, v7
    s_mul_i32 s72, s84, 4224
    s_and_b32 s73, s85, 1
    s_lshl_b32 s73, s73, 11
    s_add_u32 s72, s72, s73
    s_add_u32 s82, s72, 0x800000
    s_add_u32 s38, s68, 1
    s_and_b32 s38, s38, 7
    s_mul_i32 s38, s38, 1536
    s_add_u32 s50, s68, 2
    s_and_b32 s50, s50, 7
    s_mul_i32 s50, s50, 3072
    s_add_u32 s39, s68, 2
    s_and_b32 s39, s39, 7
    s_mul_i32 s39, s39, 1536
    s_add_u32 s51, s68, 4
    s_and_b32 s51, s51, 7
    s_mul_i32 s51, s51, 3072
    s_add_u32 s40, s68, 3
    s_and_b32 s40, s40, 7
    s_mul_i32 s40, s40, 1536
    s_add_u32 s52, s68, 6
    s_and_b32 s52, s52, 7
    s_mul_i32 s52, s52, 3072
    s_add_u32 s41, s68, 4
    s_and_b32 s41, s41, 7
    s_mul_i32 s41, s41, 1536
    s_add_u32 s53, s68, 8
    s_and_b32 s53, s53, 7
    s_mul_i32 s53, s53, 3072
    s_add_u32 s42, s68, 5
    s_and_b32 s42, s42, 7
    s_mul_i32 s42, s42, 1536
    s_mov_b32 s54, s50
    s_add_u32 s43, s68, 6
    s_and_b32 s43, s43, 7
    s_mul_i32 s43, s43, 1536
    s_mov_b32 s55, s51
    s_add_u32 s44, s68, 7
    s_and_b32 s44, s44, 7
    s_mul_i32 s44, s44, 1536
    s_mov_b32 s56, s52
    s_add_u32 s57, s68, 15
    s_and_b32 s57, s57, 7
    s_mul_i32 s57, s57, 3072
    s_mov_b32 s87, 0
    s_branch L_conv_end
L_tri2:
    ds_read_b64 v[28:29], v212 offset:0
    ds_read_b64 v[30:31], v212 offset:8
    ds_read_b128 v[36:39], v94 offset:0
    ds_read_b64 v[32:33], v212 offset:64
    ds_read_b64 v[34:35], v212 offset:72
    ds_read_b128 v[40:43], v94 offset:80
    ds_read_b64 v[12:13], v212 offset:128
    ds_read_b64 v[14:15], v212 offset:136
    ds_read_b128 v[20:23], v94 offset:160
    ds_read_b64 v[16:17], v212 offset:192
    ds_read_b64 v[18:19], v212 offset:200
    ds_read_b128 v[24:27], v94 offset:240
    s_waitcnt lgkmcnt(9)
    v_mfma_f32_32x32x16_bf16 v[216:231], v[28:31], v[36:39], 0
    ds_read_b64 v[28:29], v212 offset:256
    ds_read_b64 v[30:31], v212 offset:264
    ds_read_b128 v[36:39], v94 offset:320
    v_mov_b32 v209, 0
    s_lshl_b32 s72, s68, 12
    s_add_u32 s72, s72, 0xd04000
    v_lshl_add_u32 v214, v2, 7, s72
    v_lshl_add_u32 v214, v3, 14, v214
    s_mul_i32 s72, s68, 1536
    s_waitcnt lgkmcnt(9)
    v_mfma_f32_32x32x16_bf16 v[216:231], v[32:35], v[40:43], v[216:231]
    ds_read_b64 v[32:33], v212 offset:320
    ds_read_b64 v[34:35], v212 offset:328
    ds_read_b128 v[40:43], v94 offset:400
    s_add_u32 s72, s72, 20480
    v_mov_b32 v76, 153856
    v_add_u32 v77, s72, v4
    v_add_u32 v78, s72, v248
    v_lshl_add_u32 v79, v2, 3, s72
    s_mov_b32 s94, 0x7f7f7f7f
    s_waitcnt lgkmcnt(9)
    v_mfma_f32_32x32x16_bf16 v[216:231], v[12:15], v[20:23], v[216:231]
    ds_read_b64 v[12:13], v212 offset:384
    ds_read_b64 v[14:15], v212 offset:392
    ds_read_b128 v[20:23], v94 offset:480
    s_mov_b32 s95, 0x7f7f7f7f
    v_lshrrev_b32 v5, 3, v2
    v_lshrrev_b32 v6, 4, v2
    v_sub_u32 v6, 7, v6
    v_lshlrev_b32 v249, v6, v3
    v_lshl_add_u32 v249, v5, 9, v249
    s_waitcnt lgkmcnt(9)
    v_mfma_f32_32x32x16_bf16 v[216:231], v[16:19], v[24:27], v[216:231]
    ds_read_b64 v[16:17], v212 offset:448
    ds_read_b64 v[18:19], v212 offset:456
    ds_read_b128 v[24:27], v94 offset:560
    v_and_b32 v5, 7, v2
    v_lshl_add_u32 v249, v5, 4, v249
    v_lshl_add_u32 v250, 2, v6, v249
    s_mul_i32 s79, s68, 20480
    s_add_u32 s79, s79, 0xcb0000
    s_bfe_u32 s80, s2, 0x20003
    s_waitcnt lgkmcnt(9)
    v_mfma_f32_32x32x16_bf16 v[216:231], v[28:31], v[36:39], v[216:231]
    ds_read_b64 v[28:29], v212 offset:512
    ds_read_b64 v[30:31], v212 offset:520
    ds_read_b128 v[36:39], v94 offset:640
    v_add_u32 v80, s80, v3
    v_add_u32 v81, 2, v80
    v_and_b32 v80, 3, v80
    v_mul_u32_u24 v80, 5120, v80
    v_lshl_add_u32 v80, v2, 4, v80
    v_and_b32 v81, 3, v81
    s_waitcnt lgkmcnt(9)
    v_mfma_f32_32x32x16_bf16 v[216:231], v[32:35], v[40:43], v[216:231]
    ds_read_b64 v[32:33], v212 offset:576
    ds_read_b64 v[34:35], v212 offset:584
    ds_read_b128 v[40:43], v94 offset:720
    v_mul_u32_u24 v81, 5120, v81
    v_lshl_add_u32 v81, v2, 4, v81
    s_mov_b32 s90, 0x000fffff
    s_mov_b32 s91, 0x000fffff
    s_mov_b32 s16, s58
    s_and_b32 s17, s59, 0xffff
    s_waitcnt lgkmcnt(9)
    v_mfma_f32_32x32x16_bf16 v[216:231], v[12:15], v[20:23], v[216:231]
    ds_read_b64 v[12:13], v212 offset:640
    ds_read_b64 v[14:15], v212 offset:648
    ds_read_b128 v[20:23], v94 offset:800
    s_mov_b32 s18, 0xc8000
    s_mov_b32 s19, 0x00020000
    s_lshr_b32 s72, s2, 3
    s_lshl_b32 s72, s72, 3
    s_add_u32 s72, s72, s68
    s_mul_i32 s72, s72, 3200
    s_waitcnt lgkmcnt(9)
    v_mfma_f32_32x32x16_bf16 v[216:231], v[16:19], v[24:27], v[216:231]
    ds_read_b64 v[16:17], v212 offset:704
    ds_read_b64 v[18:19], v212 offset:712
    ds_read_b128 v[24:27], v94 offset:880
    v_min_u32 v7, 24, v1
    v_lshlrev_b32 v7, 7, v7
    buffer_load_dword v215, v7, s[16:19], s72 offen
    v_mov_b32 v44, 0
    v_mov_b32 v45, 0
    v_mov_b32 v46, 0
    s_waitcnt lgkmcnt(9)
    v_mfma_f32_32x32x16_bf16 v[216:231], v[28:31], v[36:39], v[216:231]
    ds_read_b64 v[28:29], v212 offset:768
    ds_read_b64 v[30:31], v212 offset:776
    ds_read_b128 v[36:39], v94 offset:960
    v_mov_b32 v47, 0
    v_mov_b32 v48, 0
    v_mov_b32 v49, 0
    v_mov_b32 v50, 0
    v_mov_b32 v51, 0
    v_mov_b32 v52, 0
    s_setprio 1
    s_waitcnt lgkmcnt(9)
    v_mfma_f32_32x32x16_bf16 v[216:231], v[32:35], v[40:43], v[216:231]
    ds_read_b64 v[32:33], v212 offset:832
    ds_read_b64 v[34:35], v212 offset:840
    ds_read_b128 v[40:43], v94 offset:1040
    v_mov_b32 v53, 0
    v_mov_b32 v54, 0
    v_mov_b32 v55, 0
    v_mov_b32 v56, 0
    v_mov_b32 v57, 0
    v_mov_b32 v58, 0
    s_waitcnt lgkmcnt(9)
    v_mfma_f32_32x32x16_bf16 v[216:231], v[12:15], v[20:23], v[216:231]
    ds_read_b64 v[12:13], v212 offset:896
    ds_read_b64 v[14:15], v212 offset:904
    ds_read_b128 v[20:23], v94 offset:1120
    v_mov_b32 v59, 0
    v_mov_b32 v60, 0
    v_mov_b32 v61, 0
    v_mov_b32 v62, 0
    v_mov_b32 v63, 0
    v_mov_b32 v64, 0
    s_waitcnt lgkmcnt(9)
    v_mfma_f32_32x32x16_bf16 v[216:231], v[16:19], v[24:27], v[216:231]
    ds_read_b64 v[16:17], v212 offset:960
    ds_read_b64 v[18:19], v212 offset:968
    ds_read_b128 v[24:27], v94 offset:1200
    v_mov_b32 v65, 0
    v_mov_b32 v66, 0
    v_mov_b32 v67, 0
    v_mov_b32 v68, 0
    v_mov_b32 v69, 0
    v_mov_b32 v70, 0
    s_waitcnt lgkmcnt(9)
    v_mfma_f32_32x32x16_bf16 v[216:231], v[28:31], v[36:39], v[216:231]
    ds_read_b64 v[28:29], v95 offset:0
    ds_read_b64 v[30:31], v95 offset:8
    ds_read_b128 v[36:39], v213 offset:1232
    v_mov_b32 v71, 0
    v_mov_b32 v72, 0
    v_mov_b32 v73, 0
    v_mov_b32 v74, 0
    v_mov_b32 v75, 0
    v_lshlrev_b32 v7, 6, v2
    s_waitcnt lgkmcnt(9)
    v_mfma_f32_32x32x16_bf16 v[216:231], v[32:35], v[40:43], v[216:231]
    ds_read_b64 v[32:33], v212 offset:1024
    ds_read_b64 v[34:35], v212 offset:1032
    ds_read_b128 v[40:43], v213 offset:1280
    v_lshl_add_u32 v7, v3, 4, v7
    s_cmp_ge_u32 s85, 2
    s_cselect_b32 s74, 0x80000000, 0
    v_or_b32 v9, s74, v7
    s_mul_i32 s72, s84, 4224
    s_and_b32 s73, s85, 1
    s_waitcnt lgkmcnt(9)
    v_mfma_f32_32x32x16_bf16 v[216:231], v[12:15], v[20:23], v[216:231]
    ds_read_b64 v[12:13], v212 offset:1056
    ds_read_b64 v[14:15], v212 offset:1064
    ds_read_b128 v[20:23], v213 offset:1312
    s_lshl_b32 s73, s73, 11
    s_add_u32 s72, s72, s73
    s_add_u32 s82, s72, 0x800000
    s_add_u32 s38, s68, 1
    s_and_b32 s38, s38, 7
    s_mul_i32 s38, s38, 1536
    s_waitcnt lgkmcnt(9)
    v_mfma_f32_32x32x16_bf16 v[216:231], v[16:19], v[24:27], v[216:231]
    ds_read_b64 v[16:17], v212 offset:1088
    ds_read_b64 v[18:19], v212 offset:1096
    ds_read_b128 v[24:27], v213 offset:1360
    s_add_u32 s50, s68, 2
    s_and_b32 s50, s50, 7
    s_mul_i32 s50, s50, 3072
    s_add_u32 s39, s68, 2
    s_and_b32 s39, s39, 7
    s_mul_i32 s39, s39, 1536
    s_waitcnt lgkmcnt(9)
    v_mfma_f32_32x32x16_bf16 v[232:247], v[28:31], v[36:39], 0
    ds_read_b64 v[28:29], v212 offset:1120
    ds_read_b64 v[30:31], v212 offset:1128
    ds_read_b128 v[36:39], v213 offset:1392
    s_add_u32 s51, s68, 4
    s_and_b32 s51, s51, 7
    s_mul_i32 s51, s51, 3072
    s_add_u32 s40, s68, 3
    s_and_b32 s40, s40, 7
    s_mul_i32 s40, s40, 1536
    s_waitcnt lgkmcnt(9)
    v_mfma_f32_32x32x16_bf16 v[232:247], v[32:35], v[40:43], v[232:247]
    ds_read_b64 v[32:33], v212 offset:1152
    ds_read_b64 v[34:35], v212 offset:1160
    ds_read_b128 v[40:43], v213 offset:1440
    s_add_u32 s52, s68, 6
    s_and_b32 s52, s52, 7
    s_mul_i32 s52, s52, 3072
    s_add_u32 s41, s68, 4
    s_and_b32 s41, s41, 7
    s_mul_i32 s41, s41, 1536
    s_waitcnt lgkmcnt(9)
    v_mfma_f32_32x32x16_bf16 v[232:247], v[12:15], v[20:23], v[232:247]
    ds_read_b64 v[12:13], v212 offset:1184
    ds_read_b64 v[14:15], v212 offset:1192
    ds_read_b128 v[20:23], v213 offset:1472
    s_add_u32 s53, s68, 8
    s_and_b32 s53, s53, 7
    s_mul_i32 s53, s53, 3072
    s_add_u32 s42, s68, 5
    s_and_b32 s42, s42, 7
    s_mul_i32 s42, s42, 1536
    s_waitcnt lgkmcnt(9)
    v_mfma_f32_32x32x16_bf16 v[232:247], v[16:19], v[24:27], v[232:247]
    ds_read_b64 v[16:17], v212 offset:1216
    ds_read_b64 v[18:19], v212 offset:1224
    ds_read_b128 v[24:27], v213 offset:1520
    s_mov_b32 s54, s50
    s_add_u32 s43, s68, 6
    s_and_b32 s43, s43, 7
    s_mul_i32 s43, s43, 1536
    s_mov_b32 s55, s51
    s_add_u32 s44, s68, 7
    s_waitcnt lgkmcnt(9)
    v_mfma_f32_32x32x16_bf16 v[232:247], v[28:31], v[36:39], v[232:247]
    ds_read_b64 v[28:29], v212 offset:1248
    ds_read_b64 v[30:31], v212 offset:1256
    ds_read_b128 v[36:39], v213 offset:1552
    s_and_b32 s44, s44, 7
    s_mul_i32 s44, s44, 1536
    s_mov_b32 s56, s52
    s_add_u32 s57, s68, 15
    s_and_b32 s57, s57, 7
    s_mul_i32 s57, s57, 3072
    s_waitcnt lgkmcnt(9)
    v_mfma_f32_32x32x16_bf16 v[232:247], v[32:35], v[40:43], v[232:247]
    ds_read_b64 v[32:33], v212 offset:1280
    ds_read_b64 v[34:35], v212 offset:1288
    ds_read_b128 v[40:43], v213 offset:1600
    v_mov_b32 v96, 0
    v_mov_b32 v97, 0
    v_mov_b32 v98, 0
    v_mov_b32 v99, 0
    s_waitcnt lgkmcnt(9)
    v_mfma_f32_32x32x16_bf16 v[232:247], v[12:15], v[20:23], v[232:247]
    ds_read_b64 v[12:13], v212 offset:1312
    ds_read_b64 v[14:15], v212 offset:1320
    ds_read_b128 v[20:23], v213 offset:1632
    v_mov_b32 v100, 0
    v_mov_b32 v101, 0
    v_mov_b32 v102, 0
    v_mov_b32 v103, 0
    s_waitcnt lgkmcnt(9)
    v_mfma_f32_32x32x16_bf16 v[232:247], v[16:19], v[24:27], v[232:247]
    ds_read_b64 v[16:17], v212 offset:1344
    ds_read_b64 v[18:19], v212 offset:1352
    ds_read_b128 v[24:27], v213 offset:1680
    v_mov_b32 v104, 0
    v_mov_b32 v105, 0
    v_mov_b32 v106, 0
    v_mov_b32 v107, 0
    s_waitcnt lgkmcnt(9)
    v_mfma_f32_32x32x16_bf16 v[232:247], v[28:31], v[36:39], v[232:247]
    ds_read_b64 v[28:29], v212 offset:1376
    ds_read_b64 v[30:31], v212 offset:1384
    ds_read_b128 v[36:39], v213 offset:1712
    v_mov_b32 v108, 0
    v_mov_b32 v109, 0
    v_mov_b32 v110, 0
    v_mov_b32 v111, 0
    s_waitcnt lgkmcnt(9)
    v_mfma_f32_32x32x16_bf16 v[232:247], v[32:35], v[40:43], v[232:247]
    ds_read_b64 v[32:33], v212 offset:1408
    ds_read_b64 v[34:35], v212 offset:1416
    ds_read_b128 v[40:43], v213 offset:1760
    v_permlane16_swap_b32 v96, v216
    v_permlane16_swap_b32 v97, v217
    v_permlane16_swap_b32 v98, v218
    v_permlane16_swap_b32 v99, v219
    s_waitcnt lgkmcnt(9)
    v_mfma_f32_32x32x16_bf16 v[232:247], v[12:15], v[20:23], v[232:247]
    ds_read_b64 v[12:13], v212 offset:1440
    ds_read_b64 v[14:15], v212 offset:1448
    ds_read_b128 v[20:23], v213 offset:1792
    v_permlane16_swap_b32 v100, v220
    v_permlane16_swap_b32 v101, v221
    v_permlane16_swap_b32 v102, v222
    v_permlane16_swap_b32 v103, v223
    s_waitcnt lgkmcnt(9)
    v_mfma_f32_32x32x16_bf16 v[232:247], v[16:19], v[24:27], v[232:247]
    ds_read_b64 v[16:17], v212 offset:1472
    ds_read_b64 v[18:19], v212 offset:1480
    ds_read_b128 v[24:27], v213 offset:1840
    v_permlane16_swap_b32 v104, v224
    v_permlane16_swap_b32 v105, v225
    v_permlane16_swap_b32 v106, v226
    v_permlane16_swap_b32 v107, v227
    s_waitcnt lgkmcnt(9)
    v_mfma_f32_32x32x16_bf16 v[232:247], v[28:31], v[36:39], v[232:247]
    ds_read_b64 v[28:29], v212 offset:1504
    ds_read_b64 v[30:31], v212 offset:1512
    ds_read_b128 v[36:39], v213 offset:1872
    v_permlane16_swap_b32 v108, v228
    v_permlane16_swap_b32 v109, v229
    v_permlane16_swap_b32 v110, v230
    v_permlane16_swap_b32 v111, v231
    s_waitcnt lgkmcnt(9)
    v_mfma_f32_32x32x16_bf16 v[232:247], v[32:35], v[40:43], v[232:247]
    ds_read_b64 v[32:33], v212 offset:1536
    ds_read_b64 v[34:35], v212 offset:1544
    ds_read_b128 v[40:43], v213 offset:1920
    v_add_f32 v224, v224, v96
    v_add_f32 v225, v225, v97
    v_add_f32 v226, v226, v98
    v_add_f32 v227, v227, v99
    s_waitcnt lgkmcnt(9)
    v_mfma_f32_32x32x16_bf16 v[232:247], v[12:15], v[20:23], v[232:247]
    ds_read_b64 v[12:13], v212 offset:1568
    ds_read_b64 v[14:15], v212 offset:1576
    ds_read_b128 v[20:23], v213 offset:1952
    v_add_f32 v228, v228, v100
    v_add_f32 v229, v229, v101
    v_add_f32 v230, v230, v102
    v_add_f32 v231, v231, v103
    s_cmp_lt_u32 s68, 4
    s_cbranch_scc1 L_cpt
L_cpt_e:
    s_waitcnt lgkmcnt(9)
    v_mfma_f32_32x32x16_bf16 v[232:247], v[16:19], v[24:27], v[232:247]
    ds_read_b64 v[16:17], v212 offset:1600
    ds_read_b64 v[18:19], v212 offset:1608
    ds_read_b128 v[24:27], v213 offset:2000
    v_add_f32_dpp v216, v104, v216 row_shr:1 row_mask:0xf bank_mask:0xf bound_ctrl:1
    v_add_f32_dpp v217, v105, v217 row_shr:1 row_mask:0xf bank_mask:0xf bound_ctrl:1
    v_add_f32_dpp v218, v106, v218 row_shr:1 row_mask:0xf bank_mask:0xf bound_ctrl:1
    v_add_f32_dpp v219, v107, v219 row_shr:1 row_mask:0xf bank_mask:0xf bound_ctrl:1
    s_waitcnt lgkmcnt(9)
    v_mfma_f32_32x32x16_bf16 v[232:247], v[28:31], v[36:39], v[232:247]
    ds_read_b64 v[28:29], v212 offset:1632
    ds_read_b64 v[30:31], v212 offset:1640
    ds_read_b128 v[36:39], v213 offset:2032
    v_add_f32_dpp v220, v108, v220 row_shr:1 row_mask:0xf bank_mask:0xf bound_ctrl:1
    v_add_f32_dpp v221, v109, v221 row_shr:1 row_mask:0xf bank_mask:0xf bound_ctrl:1
    v_add_f32_dpp v222, v110, v222 row_shr:1 row_mask:0xf bank_mask:0xf bound_ctrl:1
    v_add_f32_dpp v223, v111, v223 row_shr:1 row_mask:0xf bank_mask:0xf bound_ctrl:1
    s_waitcnt lgkmcnt(9)
    v_mfma_f32_32x32x16_bf16 v[232:247], v[32:35], v[40:43], v[232:247]
    ds_read_b64 v[32:33], v212 offset:1664
    ds_read_b64 v[34:35], v212 offset:1672
    ds_read_b128 v[40:43], v213 offset:2080
    s_waitcnt lgkmcnt(9)
    v_mfma_f32_32x32x16_bf16 v[232:247], v[12:15], v[20:23], v[232:247]
    ds_read_b64 v[12:13], v212 offset:1696
    ds_read_b64 v[14:15], v212 offset:1704
    ds_read_b128 v[20:23], v213 offset:2112
    s_waitcnt lgkmcnt(9)
    v_mfma_f32_32x32x16_bf16 v[232:247], v[16:19], v[24:27], v[232:247]
    ds_read_b64 v[16:17], v212 offset:1728
    ds_read_b64 v[18:19], v212 offset:1736
    ds_read_b128 v[24:27], v213 offset:2160
    ds_read_b128 v[120:123], v76 offset:48
    ds_read_b128 v[124:127], v76 offset:64
    ds_read_b128 v[84:87], v77
    ds_read_b64 v[92:93], v78 offset:1024
    ds_read_b32 v210, v79 offset:1280
    s_waitcnt lgkmcnt(9)
    v_mfma_f32_32x32x16_bf16 v[232:247], v[28:31], v[36:39], v[232:247]
    ds_read_b64 v[28:29], v212 offset:1760
    ds_read_b64 v[30:31], v212 offset:1768
    ds_read_b128 v[36:39], v213 offset:2192
    s_waitcnt lgkmcnt(9)
    v_mfma_f32_32x32x16_bf16 v[232:247], v[32:35], v[40:43], v[232:247]
    ds_read_b64 v[32:33], v212 offset:1792
    ds_read_b64 v[34:35], v212 offset:1800
    ds_read_b128 v[40:43], v213 offset:2240
    s_waitcnt lgkmcnt(9)
    v_mfma_f32_32x32x16_bf16 v[232:247], v[12:15], v[20:23], v[232:247]
    ds_read_b64 v[12:13], v212 offset:1824
    ds_read_b64 v[14:15], v212 offset:1832
    ds_read_b128 v[20:23], v213 offset:2272
    s_waitcnt lgkmcnt(9)
    v_mfma_f32_32x32x16_bf16 v[232:247], v[16:19], v[24:27], v[232:247]
    ds_read_b64 v[16:17], v212 offset:1856
    ds_read_b64 v[18:19], v212 offset:1864
    ds_read_b128 v[24:27], v213 offset:2320
    v_min_u32 v5, v120, v121
    v_min3_u32 v5, v5, v122, v123
    v_min3_u32 v5, v5, v124, v125
    v_min3_u32 v5, v5, v126, v127
    s_waitcnt lgkmcnt(9)
    v_mfma_f32_32x32x16_bf16 v[232:247], v[28:31], v[36:39], v[232:247]
    ds_read_b64 v[28:29], v212 offset:1888
    ds_read_b64 v[30:31], v212 offset:1896
    ds_read_b128 v[36:39], v213 offset:2352
    v_max3_f32 v6, v120, v121, v122
    v_max_f32 v6, v6, v123
    v_mul_f32 v210, v210, v6
    v_sqrt_f32 v210, v210
    s_waitcnt lgkmcnt(9)
    v_mfma_f32_32x32x16_bf16 v[232:247], v[32:35], v[40:43], v[232:247]
    ds_read_b64 v[32:33], v212 offset:1920
    ds_read_b64 v[34:35], v212 offset:1928
    ds_read_b128 v[40:43], v213 offset:2400
    v_readfirstlane_b32 s87, v5
    v_mul_f32 v210, 0x3f83d70a, v210
    v_and_b32 v210, s92, v210
    v_cmp_lt_f32 vcc, 0x42400000, v210
    s_waitcnt lgkmcnt(9)
    v_mfma_f32_32x32x16_bf16 v[232:247], v[12:15], v[20:23], v[232:247]
    ds_read_b64 v[12:13], v212 offset:1952
    ds_read_b64 v[14:15], v212 offset:1960
    ds_read_b128 v[20:23], v213 offset:2432
    s_cmp_lg_u64 vcc, 0
    s_cselect_b32 s87, 0, s87
    s_mov_b64 exec, s[88:89]
    v_cvt_pk_bf16_f32 v92, -v210, 0
    s_mov_b64 exec, -1
    s_cmp_lg_u32 s87, 0
    s_cbranch_scc1 L_ckt
L_ckt_e:
    s_waitcnt lgkmcnt(9)
    v_mfma_f32_32x32x16_bf16 v[232:247], v[16:19], v[24:27], v[232:247]
    ds_read_b64 v[16:17], v212 offset:1984
    ds_read_b64 v[18:19], v212 offset:1992
    ds_read_b128 v[24:27], v213 offset:2480
    s_waitcnt lgkmcnt(9)
    v_mfma_f32_32x32x16_bf16 v[232:247], v[28:31], v[36:39], v[232:247]
    ds_read_b64 v[28:29], v212 offset:2016
    ds_read_b64 v[30:31], v212 offset:2024
    ds_read_b128 v[36:39], v213 offset:2512
    s_waitcnt lgkmcnt(9)
    v_mfma_f32_32x32x16_bf16 v[232:247], v[32:35], v[40:43], v[232:247]
    s_waitcnt lgkmcnt(6)
    v_mfma_f32_32x32x16_bf16 v[232:247], v[12:15], v[20:23], v[232:247]
    s_waitcnt lgkmcnt(3)
    v_mfma_f32_32x32x16_bf16 v[232:247], v[16:19], v[24:27], v[232:247]
    s_waitcnt lgkmcnt(0)
    v_mfma_f32_32x32x16_bf16 v[232:247], v[28:31], v[36:39], v[232:247]
    s_nop 11
    v_add_f32 v232, v232, v216
    v_add_f32 v233, v233, v217
    v_add_f32 v234, v234, v218
    v_add_f32 v235, v235, v219
    v_add_f32 v236, v236, v220
    v_add_f32 v237, v237, v221
    v_add_f32 v238, v238, v222
    v_add_f32 v239, v239, v223
    v_add_f32 v240, v240, v224
    v_add_f32 v241, v241, v225
    v_add_f32 v242, v242, v226
    v_add_f32 v243, v243, v227
    v_add_f32 v244, v244, v228
    v_add_f32 v245, v245, v229
    v_add_f32 v246, v246, v230
    v_add_f32 v247, v247, v231
L_conv_end:
    v_mov_b32 v213, v78
    v_mov_b32 v212, v76
    s_cmp_lg_u32 s87, 0
    s_cbranch_scc1 L_ringfree
    v_mov_b32 v8, 153856
    s_mov_b32 s75, 3000000
L_hx:
    ds_read_b128 v[120:123], v8 offset:16
    s_sub_u32 s75, s75, 1
    s_cmp_eq_u32 s75, 0
    s_cbranch_scc1 L_end
    s_waitcnt lgkmcnt(0)
    v_min_u32 v120, v120, v121
    v_min3_u32 v120, v120, v122, v123
    s_nop 0
    v_readfirstlane_b32 s74, v120
    s_nop 0
    s_cmp_ge_u32 s74, 10
    s_cbranch_scc1 L_hx_ok
    s_sleep 1
    s_branch L_hx
L_hx_ok:
L_ringfree:
    s_cmp_lg_u32 s85, 2
    s_cbranch_scc1 L_conv_done
    s_lshr_b32 s72, s68, 1
    s_lshl_b32 s73, s72, 12
    v_add_u32 v5, s73, v4
    v_lshl_add_u32 v6, s72, 2, v212
    s_nop 0
    ds_write_b128 v5, v[232:235] offset:40960
    ds_write_b128 v5, v[236:239] offset:41984
    ds_write_b128 v5, v[240:243] offset:43008
    ds_write_b128 v5, v[244:247] offset:44032
    ds_write_b32 v6, v6 offset:80
L_conv_done:
    s_cmp_lg_u32 s87, 0
    s_cbranch_scc1 L_started
    s_cmp_ge_u32 s68, 4
    s_cbranch_scc1 L_late
    s_setprio 0
    s_mul_i32 s73, s69, 81920
    s_mul_i32 s74, s70, 160
    s_add_u32 s73, s73, s74
    s_lshl_b32 s72, s68, 6
    s_add_u32 s72, s72, 0
    v_add_u32 v7, s72, v1
    v_mul_u32_u24 v6, 6554, v7
    v_lshrrev_b32 v6, 16, v6
    v_mul_u32_u24 v6, 1120, v6
    s_lshl_b32 s72, s72, 4
    s_add_u32 m0, s72, 0
    v_lshl_add_u32 v7, v7, 4, v6
    buffer_load_dwordx4 v7, s[12:15], s73 offen lds
    s_lshl_b32 s72, s68, 6
    s_add_u32 s72, s72, 256
    v_add_u32 v7, s72, v1
    v_mul_u32_u24 v6, 6554, v7
    v_lshrrev_b32 v6, 16, v6
    v_mul_u32_u24 v6, 1120, v6
    s_lshl_b32 s72, s72, 4
    s_add_u32 m0, s72, 0
    v_lshl_add_u32 v7, v7, 4, v6
    buffer_load_dwordx4 v7, s[12:15], s73 offen lds
    s_cmp_ge_u32 s68, 2
    s_cbranch_scc1 L_ud
    s_lshl_b32 s72, s68, 6
    s_add_u32 s72, s72, 512
    v_add_u32 v7, s72, v1
    v_mul_u32_u24 v6, 6554, v7
    v_lshrrev_b32 v6, 16, v6
    v_mul_u32_u24 v6, 1120, v6
    s_lshl_b32 s72, s72, 4
    s_add_u32 m0, s72, 0
    v_lshl_add_u32 v7, v7, 4, v6
    buffer_load_dwordx4 v7, s[12:15], s73 offen lds
    s_branch L_nou
L_ud:
    s_mov_b32 s20, s48
    s_and_b32 s21, s49, 0xffff
    s_mov_b32 s22, 0x500
    s_mov_b32 s23, 0x00020000
    s_mov_b32 m0, 162304
    s_mov_b64 exec, 0xfff
    buffer_load_dwordx4 v4, s[20:23], s74 offen lds
    s_mov_b64 exec, -1
L_nou:
    s_waitcnt vmcnt(0)
    s_mov_b64 exec, s[94:95]
    s_mov_b32 s75, 100000
    s_branch L_pk_chk
L_pk_retry:
    buffer_load_dwordx2 v[208:209], v214, s[8:11], 0 offen sc1
    s_waitcnt vmcnt(0)
L_pk_chk:
    v_cmp_ne_u32 vcc, s71, v208
    s_nop 4
    s_cbranch_vccz L_pk_ok
    s_mov_b64 exec, vcc
    s_sleep 2
    s_sub_u32 s75, s75, 1
    s_cmp_lg_u32 s75, 0
    s_cbranch_scc1 L_pk_retry
    s_endpgm
L_pk_ok:
    s_mov_b64 exec, -1
    v_add_f32_dpp v209, v209, v209 quad_perm:[1,0,3,2] row_mask:0xf bank_mask:0xf
    s_nop 1
    v_add_f32_dpp v209, v209, v209 quad_perm:[2,3,0,1] row_mask:0xf bank_mask:0xf
    s_nop 1
    v_max_f32_dpp v209, v209, v209 row_ror:8 row_mask:0xf bank_mask:0xf
    s_nop 1
    v_max_f32_dpp v209, v209, v209 row_ror:4 row_mask:0xf bank_mask:0xf
    s_nop 1
    v_max_f32_dpp v209, v209, v209 row_ror:2 row_mask:0xf bank_mask:0xf
    s_nop 1
    v_max_f32_dpp v209, v209, v209 row_ror:1 row_mask:0xf bank_mask:0xf
    v_mov_b32 v5, v209
    s_nop 1
    v_permlane16_swap_b32 v209, v5
    v_max_f32 v209, v209, v5
    v_mov_b32 v5, v209
    s_nop 1
    v_permlane32_swap_b32 v209, v5
    v_max_f32 v209, v209, v5
    v_lshl_add_u32 v5, s68, 2, v212
    v_or_b32 v209, 1, v209
    ds_write_b32 v5, v209 offset:48
    buffer_load_dwordx4 v[128:131], v80, s[8:11], s79 offen offset:2048 sc1
    buffer_load_dwordx4 v[136:139], v81, s[8:11], s79 offen offset:2048 sc1
    s_mul_i32 s78, s80, 5120
    s_add_u32 s80, s80, 1
    s_add_u32 s78, s78, s79
    s_and_b32 s80, s80, 3
    buffer_load_dwordx4 v[96:99], v4, s[8:11], s78 offen offset:0 sc1
    s_mov_b64 exec, s[90:91]
    buffer_load_dwordx4 v[144:147], v249, s[8:11], s78 offen offset:2560 sc1
    buffer_load_dwordx4 v[148:151], v250, s[8:11], s78 offen offset:2560 sc1
    s_mov_b64 exec, -1
    buffer_load_dwordx4 v[100:103], v4, s[8:11], s78 offen offset:1024 sc1
    s_mov_b64 exec, s[90:91]
    buffer_load_dwordx4 v[152:155], v249, s[8:11], s78 offen offset:3840 sc1
    buffer_load_dwordx4 v[156:159], v250, s[8:11], s78 offen offset:3840 sc1
    s_mov_b64 exec, -1
    s_mul_i32 s78, s80, 5120
    s_add_u32 s80, s80, 1
    s_add_u32 s78, s78, s79
    s_and_b32 s80, s80, 3
    buffer_load_dwordx4 v[104:107], v4, s[8:11], s78 offen offset:0 sc1
    s_mov_b64 exec, s[90:91]
    buffer_load_dwordx4 v[160:163], v249, s[8:11], s78 offen offset:2560 sc1
    buffer_load_dwordx4 v[164:167], v250, s[8:11], s78 offen offset:2560 sc1
    s_mov_b64 exec, -1
L_late:
    s_mov_b32 s75, 3000000
L_rw:
    ds_read_b128 v[120:123], v76 offset:48
    ds_read_b128 v[124:127], v76 offset:64
    ds_read_b128 v[84:87], v77
    ds_read_b64 v[92:93], v78 offset:1024
    ds_read_b32 v210, v79 offset:1280
    s_sub_u32 s75, s75, 1
    s_cmp_eq_u32 s75, 0
    s_cbranch_scc1 L_end
    s_waitcnt lgkmcnt(0)
    v_min_u32 v5, v120, v121
    v_min3_u32 v5, v5, v122, v123
    v_min3_u32 v5, v5, v124, v125
    v_min3_u32 v5, v5, v126, v127
    v_max3_f32 v6, v120, v121, v122
    v_max_f32 v6, v6, v123
    v_mul_f32 v210, v210, v6
    v_sqrt_f32 v210, v210
    v_readfirstlane_b32 s87, v5
    v_mul_f32 v210, 0x3f83d70a, v210
    v_and_b32 v210, s92, v210
    v_cmp_lt_f32 vcc, 0x42400000, v210
    s_cmp_lg_u32 s87, 0
    s_cbranch_scc1 L_rw_ok
    s_sleep 1
    s_branch L_rw
L_rw_ok:
    s_cmp_lt_u32 s68, 4
    s_cbranch_scc1 L_e67
    buffer_load_dwordx4 v[128:131], v80, s[8:11], s79 offen offset:2048 sc1
    buffer_load_dwordx4 v[136:139], v81, s[8:11], s79 offen offset:2048 sc1
    s_mul_i32 s78, s80, 5120
    s_add_u32 s80, s80, 1
    s_add_u32 s78, s78, s79
    s_and_b32 s80, s80, 3
    buffer_load_dwordx4 v[96:99], v4, s[8:11], s78 offen offset:0 sc1
    s_mov_b64 exec, s[90:91]
    buffer_load_dwordx4 v[144:147], v249, s[8:11], s78 offen offset:2560 sc1
    buffer_load_dwordx4 v[148:151], v250, s[8:11], s78 offen offset:2560 sc1
    s_mov_b64 exec, -1
    buffer_load_dwordx4 v[100:103], v4, s[8:11], s78 offen offset:1024 sc1
    s_mov_b64 exec, s[90:91]
    buffer_load_dwordx4 v[152:155], v249, s[8:11], s78 offen offset:3840 sc1
    buffer_load_dwordx4 v[156:159], v250, s[8:11], s78 offen offset:3840 sc1
    s_mov_b64 exec, -1
    s_mul_i32 s78, s80, 5120
    s_add_u32 s80, s80, 1
    s_add_u32 s78, s78, s79
    s_and_b32 s80, s80, 3
    buffer_load_dwordx4 v[104:107], v4, s[8:11], s78 offen offset:0 sc1
    s_mov_b64 exec, s[90:91]
    buffer_load_dwordx4 v[160:163], v249, s[8:11], s78 offen offset:2560 sc1
    buffer_load_dwordx4 v[164:167], v250, s[8:11], s78 offen offset:2560 sc1
    s_mov_b64 exec, -1
    s_branch L_kv_have
L_e67:
L_kv_have:
    s_nop 0
    s_cbranch_vccz L_fast
    v_mov_b32 v210, 0
    v_cndmask_b32 v92, v92, v210, s[88:89]
    v_mov_b32 v210, 0xff800000
    s_mov_b32 s72, 0xcb0000
    s_mov_b32 s75, 32
    v_lshlrev_b32 v7, 4, v2
L_fb:
    buffer_load_dwordx4 v[88:91], v4, s[8:11], s72 offen offset:0 sc1
    buffer_load_dwordx2 v[94:95], v7, s[8:11], s72 offen offset:2048 sc1
    s_waitcnt vmcnt(0)
    v_mfma_f32_32x32x16_bf16 v[28:43], v[88:91], v[84:87], 0
    v_mfma_f32_32x32x8_bf16 v[28:43], v[94:95], v[92:93], v[28:43]
    s_nop 11
    v_max3_f32 v210, v28, v29, v210
    v_max3_f32 v210, v30, v31, v210
    v_max3_f32 v210, v32, v33, v210
    v_max3_f32 v210, v34, v35, v210
    v_max3_f32 v210, v36, v37, v210
    v_max3_f32 v210, v38, v39, v210
    v_max3_f32 v210, v40, v41, v210
    v_max3_f32 v210, v42, v43, v210
    buffer_load_dwordx4 v[88:91], v4, s[8:11], s72 offen offset:1024 sc1
    buffer_load_dwordx2 v[94:95], v7, s[8:11], s72 offen offset:2056 sc1
    s_waitcnt vmcnt(0)
    v_mfma_f32_32x32x16_bf16 v[28:43], v[88:91], v[84:87], 0
    v_mfma_f32_32x32x8_bf16 v[28:43], v[94:95], v[92:93], v[28:43]
    s_nop 11
    v_max3_f32 v210, v28, v29, v210
    v_max3_f32 v210, v30, v31, v210
    v_max3_f32 v210, v32, v33, v210
    v_max3_f32 v210, v34, v35, v210
    v_max3_f32 v210, v36, v37, v210
    v_max3_f32 v210, v38, v39, v210
    v_max3_f32 v210, v40, v41, v210
    v_max3_f32 v210, v42, v43, v210
    s_add_u32 s72, s72, 5120
    s_sub_u32 s75, s75, 1
    s_cmp_lg_u32 s75, 0
    s_cbranch_scc1 L_fb
    v_mov_b32 v5, v210
    s_nop 1
    v_permlane32_swap_b32 v210, v5
    v_max_f32 v210, v210, v5
L_fast:
    v_and_b32 v5, s92, v210
    v_sub_f32 v210, v210, v5
    v_and_b32 v6, s92, v210
    v_sub_f32 v210, v210, v6
    s_mov_b64 exec, s[88:89]
    v_cvt_pk_bf16_f32 v92, -v5, -v6
    v_cvt_pk_bf16_f32 v93, -v210, 0
    s_mov_b64 exec, -1
L_started:
    ds_write_b64 v213, v[92:93] offset:1024
    s_cmp_lg_u32 s85, 1
    s_cbranch_scc1 L_nox
    s_add_u32 s72, s68, 1
    s_lshr_b32 s72, s72, 1
    s_lshl_b32 s73, s72, 12
    v_add_u32 v5, s73, v4
    v_lshl_add_u32 v6, s72, 2, v212
    s_mov_b32 s75, 3000000
L_xw:
    ds_read_b32 v7, v6 offset:80
    ds_read_b128 v[216:219], v5 offset:40960
    ds_read_b128 v[220:223], v5 offset:41984
    ds_read_b128 v[224:227], v5 offset:43008
    ds_read_b128 v[228:231], v5 offset:44032
    s_sub_u32 s75, s75, 1
    s_cmp_eq_u32 s75, 0
    s_cbranch_scc1 L_end
    s_waitcnt lgkmcnt(0)
    v_readfirstlane_b32 s72, v7
    s_nop 0
    s_cmp_eq_u32 s72, 0
    s_cbranch_scc1 L_xw
    v_add_f32 v232, v232, v216
    v_add_f32 v233, v233, v217
    v_add_f32 v234, v234, v218
    v_add_f32 v235, v235, v219
    v_add_f32 v236, v236, v220
    v_add_f32 v237, v237, v221
    v_add_f32 v238, v238, v222
    v_add_f32 v239, v239, v223
    v_add_f32 v240, v240, v224
    v_add_f32 v241, v241, v225
    v_add_f32 v242, v242, v226
    v_add_f32 v243, v243, v227
    v_add_f32 v244, v244, v228
    v_add_f32 v245, v245, v229
    v_add_f32 v246, v246, v230
    v_add_f32 v247, v247, v231
L_nox:
    s_waitcnt vmcnt(8)
    v_mfma_f32_32x32x16_bf16 v[12:27], v[96:99], v[84:87], 0
    v_permlane32_swap_b32 v128, v132
    v_permlane32_swap_b32 v129, v133
    v_permlane32_swap_b32 v130, v134
    v_permlane32_swap_b32 v131, v135
    v_permlane32_swap_b32 v136, v140
    v_permlane32_swap_b32 v137, v141
    v_permlane32_swap_b32 v138, v142
    v_permlane32_swap_b32 v139, v143
    v_mfma_f32_32x32x8_bf16 v[12:27], v[128:129], v[92:93], v[12:27]
    v_cvt_pk_bf16_f32 v76, v232, v233
    v_cvt_pk_bf16_f32 v77, v234, v235
    v_cvt_pk_bf16_f32 v78, v236, v237
    v_cvt_pk_bf16_f32 v79, v238, v239
    v_cvt_pk_bf16_f32 v80, v240, v241
    v_cvt_pk_bf16_f32 v81, v242, v243
    v_cvt_pk_bf16_f32 v82, v244, v245
    v_cvt_pk_bf16_f32 v83, v246, v247
    v_permlane32_swap_b32 v76, v78
    v_permlane32_swap_b32 v77, v79
    v_permlane32_swap_b32 v80, v82
    v_permlane32_swap_b32 v81, v83
    v_mov_b32 v210, 0xdddddddd
    v_add_u32 v214, 137472, v4
    s_waitcnt vmcnt(5)
    v_mfma_f32_32x32x16_bf16 v[28:43], v[100:103], v[84:87], 0
    buffer_load_dwordx4 v[108:111], v4, s[8:11], s78 offen offset:1024 sc1
    s_mov_b64 exec, s[90:91]
    buffer_load_dwordx4 v[168:171], v249, s[8:11], s78 offen offset:3840 sc1
    buffer_load_dwordx4 v[172:175], v250, s[8:11], s78 offen offset:3840 sc1
    s_mov_b64 exec, -1
    v_exp_f32 v12, v12
    v_exp_f32 v13, v13
    v_exp_f32 v14, v14
    v_exp_f32 v15, v15
    v_mfma_f32_32x32x8_bf16 v[28:43], v[130:131], v[92:93], v[28:43]
    v_exp_f32 v16, v16
    v_exp_f32 v17, v17
    v_exp_f32 v18, v18
    v_exp_f32 v19, v19
    v_exp_f32 v20, v20
    v_exp_f32 v21, v21
    v_exp_f32 v22, v22
    v_exp_f32 v23, v23
    v_smfmac_f32_32x32x32_bf16 v[44:59], v[144:147], v[12:19], v210
    v_exp_f32 v24, v24
    v_exp_f32 v25, v25
    v_exp_f32 v26, v26
    v_exp_f32 v27, v27
    s_waitcnt vmcnt(5)
    v_mfma_f32_32x32x16_bf16 v[216:231], v[104:107], v[84:87], 0
    s_mul_i32 s78, s80, 5120
    s_add_u32 s80, s80, 1
    s_add_u32 s78, s78, s79
    s_and_b32 s80, s80, 3
    buffer_load_dwordx4 v[112:115], v4, s[8:11], s78 offen offset:0 sc1
    s_mov_b64 exec, s[90:91]
    buffer_load_dwordx4 v[176:179], v249, s[8:11], s78 offen offset:2560 sc1
    buffer_load_dwordx4 v[180:183], v250, s[8:11], s78 offen offset:2560 sc1
    s_mov_b64 exec, -1
    v_exp_f32 v28, v28
    v_exp_f32 v29, v29
    v_exp_f32 v30, v30
    v_exp_f32 v31, v31
    v_mfma_f32_32x32x8_bf16 v[216:231], v[132:133], v[92:93], v[216:231]
    v_exp_f32 v32, v32
    v_exp_f32 v33, v33
    v_exp_f32 v34, v34
    v_exp_f32 v35, v35
    v_smfmac_f32_32x32x32_bf16 v[44:59], v[148:151], v[20:27], v210
    v_exp_f32 v36, v36
    v_exp_f32 v37, v37
    v_exp_f32 v38, v38
    v_exp_f32 v39, v39
    v_smfmac_f32_32x32x32_bf16 v[44:59], v[152:155], v[28:35], v210
    v_exp_f32 v40, v40
    v_exp_f32 v41, v41
    v_exp_f32 v42, v42
    v_exp_f32 v43, v43
    s_waitcnt vmcnt(5)
    v_mfma_f32_32x32x16_bf16 v[232:247], v[108:111], v[84:87], 0
    buffer_load_dwordx4 v[116:119], v4, s[8:11], s78 offen offset:1024 sc1
    s_mov_b64 exec, s[90:91]
    buffer_load_dwordx4 v[184:187], v249, s[8:11], s78 offen offset:3840 sc1
    buffer_load_dwordx4 v[188:191], v250, s[8:11], s78 offen offset:3840 sc1
    s_mov_b64 exec, -1
    v_exp_f32 v216, v216
    v_exp_f32 v217, v217
    v_exp_f32 v218, v218
    v_exp_f32 v219, v219
    v_mfma_f32_32x32x8_bf16 v[232:247], v[134:135], v[92:93], v[232:247]
    v_exp_f32 v220, v220
    v_exp_f32 v221, v221
    v_exp_f32 v222, v222
    v_exp_f32 v223, v223
    v_smfmac_f32_32x32x32_bf16 v[44:59], v[156:159], v[36:43], v210
    v_exp_f32 v224, v224
    v_exp_f32 v225, v225
    v_exp_f32 v226, v226
    v_exp_f32 v227, v227
    v_smfmac_f32_32x32x32_bf16 v[44:59], v[160:163], v[216:223], v210
    v_exp_f32 v228, v228
    v_exp_f32 v229, v229
    v_exp_f32 v230, v230
    v_exp_f32 v231, v231
    s_waitcnt vmcnt(5)
    v_mfma_f32_32x32x16_bf16 v[12:27], v[112:115], v[84:87], 0
    v_add_u32 v212, s38, v4
    s_mul_i32 s78, s80, 5120
    s_add_u32 s80, s80, 1
    s_add_u32 s78, s78, s79
    s_and_b32 s80, s80, 3
    buffer_load_dwordx4 v[120:123], v4, s[8:11], s78 offen offset:0 sc1
    s_mov_b64 exec, s[90:91]
    buffer_load_dwordx4 v[192:195], v249, s[8:11], s78 offen offset:2560 sc1
    buffer_load_dwordx4 v[196:199], v250, s[8:11], s78 offen offset:2560 sc1
    s_mov_b64 exec, -1
    v_exp_f32 v232, v232
    v_exp_f32 v233, v233
    v_exp_f32 v234, v234
    v_exp_f32 v235, v235
    v_mfma_f32_32x32x8_bf16 v[12:27], v[136:137], v[92:93], v[12:27]
    v_add_u32 v211, s50, v214
    v_exp_f32 v236, v236
    v_exp_f32 v237, v237
    v_exp_f32 v238, v238
    v_exp_f32 v239, v239
    v_smfmac_f32_32x32x32_bf16 v[44:59], v[164:167], v[224:231], v210
    v_add_u32 v213, s38, v248
    v_exp_f32 v240, v240
    v_exp_f32 v241, v241
    v_exp_f32 v242, v242
    v_exp_f32 v243, v243
    v_smfmac_f32_32x32x32_bf16 v[44:59], v[168:171], v[232:239], v210
    v_exp_f32 v244, v244
    v_exp_f32 v245, v245
    v_exp_f32 v246, v246
    v_exp_f32 v247, v247
    s_waitcnt vmcnt(5)
    s_waitcnt lgkmcnt(0)
    s_barrier
    v_mfma_f32_32x32x16_bf16 v[28:43], v[116:119], v[84:87], 0
    s_setprio 3
    buffer_load_dwordx4 v[124:127], v4, s[8:11], s78 offen offset:1024 sc1
    s_mov_b64 exec, s[90:91]
    buffer_load_dwordx4 v[200:203], v249, s[8:11], s78 offen offset:3840 sc1
    buffer_load_dwordx4 v[204:207], v250, s[8:11], s78 offen offset:3840 sc1
    s_mov_b64 exec, -1
    v_exp_f32 v12, v12
    v_exp_f32 v13, v13
    v_exp_f32 v14, v14
    v_exp_f32 v15, v15
    v_mfma_f32_32x32x8_bf16 v[28:43], v[138:139], v[92:93], v[28:43]
    ds_read_b128 v[88:91], v212 offset:20480
    v_exp_f32 v16, v16
    v_exp_f32 v17, v17
    v_exp_f32 v18, v18
    v_exp_f32 v19, v19
    v_smfmac_f32_32x32x32_bf16 v[44:59], v[172:175], v[240:247], v210
    ds_read_b64 v[94:95], v213 offset:21504
    v_exp_f32 v20, v20
    v_exp_f32 v21, v21
    v_exp_f32 v22, v22
    v_exp_f32 v23, v23
    v_smfmac_f32_32x32x32_bf16 v[44:59], v[176:179], v[12:19], v210
    v_exp_f32 v24, v24
    v_exp_f32 v25, v25
    v_exp_f32 v26, v26
    v_exp_f32 v27, v27
    s_waitcnt vmcnt(5)
    v_mfma_f32_32x32x16_bf16 v[216:231], v[120:123], v[84:87], 0
    buffer_store_dwordx4 v[76:79], v9, s[8:11], s82 offen sc1
    v_exp_f32 v28, v28
    v_exp_f32 v29, v29
    v_exp_f32 v30, v30
    v_exp_f32 v31, v31
    v_mfma_f32_32x32x8_bf16 v[216:231], v[140:141], v[92:93], v[216:231]
    buffer_store_dwordx4 v[80:83], v9, s[8:11], s82 offen offset:32 sc1
    v_exp_f32 v32, v32
    v_exp_f32 v33, v33
    v_exp_f32 v34, v34
    v_exp_f32 v35, v35
    v_smfmac_f32_32x32x32_bf16 v[44:59], v[180:183], v[20:27], v210
    v_mul_u32_u24 v6, 6554, v1
    s_mul_i32 s3, s70, 160
    v_exp_f32 v36, v36
    v_exp_f32 v37, v37
    v_exp_f32 v38, v38
    v_exp_f32 v39, v39
    v_smfmac_f32_32x32x32_bf16 v[44:59], v[184:187], v[28:35], v210
    v_lshrrev_b32 v6, 16, v6
    s_and_b32 s72, s68, 3
    v_exp_f32 v40, v40
    v_exp_f32 v41, v41
    v_exp_f32 v42, v42
    v_exp_f32 v43, v43
    s_waitcnt vmcnt(4)
    v_mfma_f32_32x32x16_bf16 v[232:247], v[124:127], v[84:87], 0
    s_setprio 2
    v_exp_f32 v216, v216
    v_exp_f32 v217, v217
    v_exp_f32 v218, v218
    v_exp_f32 v219, v219
    v_mfma_f32_32x32x8_bf16 v[232:247], v[142:143], v[92:93], v[232:247]
    v_mul_u32_u24 v6, 4960, v6
    s_lshr_b32 s7, s68, 2
    v_exp_f32 v220, v220
    v_exp_f32 v221, v221
    v_exp_f32 v222, v222
    v_exp_f32 v223, v223
    v_smfmac_f32_32x32x32_bf16 v[44:59], v[188:191], v[36:43], v210
    v_add_u32 v215, v6, v4
    s_mul_i32 s83, s72, 26176
    v_exp_f32 v224, v224
    v_exp_f32 v225, v225
    v_exp_f32 v226, v226
    v_exp_f32 v227, v227
    v_smfmac_f32_32x32x32_bf16 v[44:59], v[192:195], v[216:223], v210
    s_mul_i32 s73, s7, 960
    s_add_u32 s83, s83, s73
    v_exp_f32 v228, v228
    v_exp_f32 v229, v229
    v_exp_f32 v230, v230
    v_exp_f32 v231, v231
    s_waitcnt vmcnt(2)
    s_waitcnt lgkmcnt(0)
    v_mfma_f32_32x32x16_bf16 v[12:27], v[96:99], v[88:91], 0
    s_mul_i32 s72, s72, 1280
    s_add_u32 s3, s3, s72
    v_exp_f32 v232, v232
    v_exp_f32 v233, v233
    v_exp_f32 v234, v234
    v_exp_f32 v235, v235
    v_mfma_f32_32x32x8_bf16 v[12:27], v[128:129], v[94:95], v[12:27]
    s_mul_i32 s72, s7, 30720
    s_add_u32 s3, s3, s72
    v_exp_f32 v236, v236
    v_exp_f32 v237, v237
    v_exp_f32 v238, v238
    v_exp_f32 v239, v239
    v_smfmac_f32_32x32x32_bf16 v[44:59], v[196:199], v[224:231], v210
    v_exp_f32 v240, v240
    v_exp_f32 v241, v241
    v_exp_f32 v242, v242
    v_exp_f32 v243, v243
    v_smfmac_f32_32x32x32_bf16 v[44:59], v[200:203], v[232:239], v210
    v_exp_f32 v244, v244
    v_exp_f32 v245, v245
    v_exp_f32 v246, v246
    v_exp_f32 v247, v247
    v_mfma_f32_32x32x16_bf16 v[28:43], v[100:103], v[88:91], 0
    s_setprio 1
    v_exp_f32 v12, v12
    v_exp_f32 v13, v13
    v_exp_f32 v14, v14
    v_exp_f32 v15, v15
    v_mfma_f32_32x32x8_bf16 v[28:43], v[130:131], v[94:95], v[28:43]
    s_lshl_b32 s74, s69, 1
    s_and_b32 s72, s68, 1
    v_exp_f32 v16, v16
    v_exp_f32 v17, v17
    v_exp_f32 v18, v18
    v_exp_f32 v19, v19
    v_smfmac_f32_32x32x32_bf16 v[44:59], v[204:207], v[240:247], v210
    s_add_u32 s74, s74, s72
    s_mul_i32 s77, s74, 40960
    v_exp_f32 v20, v20
    v_exp_f32 v21, v21
    v_exp_f32 v22, v22
    v_exp_f32 v23, v23
    v_smfmac_f32_32x32x32_bf16 v[60:75], v[144:147], v[12:19], v210
    s_lshl_b32 s74, s74, 8
    s_add_u32 s74, s74, 0x7b0000
    v_exp_f32 v24, v24
    v_exp_f32 v25, v25
    v_exp_f32 v26, v26
    v_exp_f32 v27, v27
    v_mfma_f32_32x32x16_bf16 v[216:231], v[104:107], v[88:91], 0
    v_lshlrev_b32 v6, 3, v2
    buffer_load_dwordx2 v[10:11], v6, s[8:11], s74 offen sc1
    v_exp_f32 v28, v28
    v_exp_f32 v29, v29
    v_exp_f32 v30, v30
    v_exp_f32 v31, v31
    v_mfma_f32_32x32x8_bf16 v[216:231], v[132:133], v[94:95], v[216:231]
    s_add_u32 m0, s83, 32768
    s_add_u32 s74, s3, 0
    buffer_load_dwordx4 v215, s[16:19], s74 offen lds
    v_exp_f32 v32, v32
    v_exp_f32 v33, v33
    v_exp_f32 v34, v34
    v_exp_f32 v35, v35
    v_smfmac_f32_32x32x32_bf16 v[60:75], v[148:151], v[20:27], v210
    ds_write_b128 v211, v[44:47] offset:0
    v_exp_f32 v36, v36
    v_exp_f32 v37, v37
    v_exp_f32 v38, v38
    v_exp_f32 v39, v39
    v_smfmac_f32_32x32x32_bf16 v[60:75], v[152:155], v[28:35], v210
    ds_write_b128 v211, v[48:51] offset:1024
    v_exp_f32 v40, v40
    v_exp_f32 v41, v41
    v_exp_f32 v42, v42
    v_exp_f32 v43, v43
    v_mfma_f32_32x32x16_bf16 v[232:247], v[108:111], v[88:91], 0
    s_setprio 0
    v_exp_f32 v216, v216
    v_exp_f32 v217, v217
    v_exp_f32 v218, v218
    v_exp_f32 v219, v219
    v_mfma_f32_32x32x8_bf16 v[232:247], v[134:135], v[94:95], v[232:247]
    ds_write_b128 v211, v[52:55] offset:2048
    v_exp_f32 v220, v220
    v_exp_f32 v221, v221
    v_exp_f32 v222, v222
    v_exp_f32 v223, v223
    v_smfmac_f32_32x32x32_bf16 v[60:75], v[156:159], v[36:43], v210
    v_exp_f32 v224, v224
    v_exp_f32 v225, v225
    v_exp_f32 v226, v226
    v_exp_f32 v227, v227
    v_smfmac_f32_32x32x32_bf16 v[60:75], v[160:163], v[216:223], v210
    v_exp_f32 v228, v228
    v_exp_f32 v229, v229
    v_exp_f32 v230, v230
    v_exp_f32 v231, v231
    v_mfma_f32_32x32x16_bf16 v[12:27], v[112:115], v[88:91], 0
    v_add_u32 v212, s39, v4
    v_exp_f32 v232, v232
    v_exp_f32 v233, v233
    v_exp_f32 v234, v234
    v_exp_f32 v235, v235
    v_mfma_f32_32x32x8_bf16 v[12:27], v[136:137], v[94:95], v[12:27]
    v_add_u32 v211, s51, v214
    v_exp_f32 v236, v236
    v_exp_f32 v237, v237
    v_exp_f32 v238, v238
    v_exp_f32 v239, v239
    v_smfmac_f32_32x32x32_bf16 v[60:75], v[164:167], v[224:231], v210
    v_add_u32 v213, s39, v248
    v_exp_f32 v240, v240
    v_exp_f32 v241, v241
    v_exp_f32 v242, v242
    v_exp_f32 v243, v243
    v_smfmac_f32_32x32x32_bf16 v[60:75], v[168:171], v[232:239], v210
    v_exp_f32 v244, v244
    v_exp_f32 v245, v245
    v_exp_f32 v246, v246
    v_exp_f32 v247, v247
    s_waitcnt lgkmcnt(0)
    s_barrier
    v_mfma_f32_32x32x16_bf16 v[28:43], v[116:119], v[88:91], 0
    s_setprio 3
    v_exp_f32 v12, v12
    v_exp_f32 v13, v13
    v_exp_f32 v14, v14
    v_exp_f32 v15, v15
    v_mfma_f32_32x32x8_bf16 v[28:43], v[138:139], v[94:95], v[28:43]
    ds_read_b128 v[44:47], v211 offset:0
    v_exp_f32 v16, v16
    v_exp_f32 v17, v17
    v_exp_f32 v18, v18
    v_exp_f32 v19, v19
    v_smfmac_f32_32x32x32_bf16 v[60:75], v[172:175], v[240:247], v210
    ds_read_b128 v[48:51], v211 offset:1024
    v_exp_f32 v20, v20
    v_exp_f32 v21, v21
    v_exp_f32 v22, v22
    v_exp_f32 v23, v23
    v_smfmac_f32_32x32x32_bf16 v[60:75], v[176:179], v[12:19], v210
    ds_read_b128 v[52:55], v211 offset:2048
    v_exp_f32 v24, v24
    v_exp_f32 v25, v25
    v_exp_f32 v26, v26
    v_exp_f32 v27, v27
    v_mfma_f32_32x32x16_bf16 v[216:231], v[120:123], v[88:91], 0
    ds_read_b128 v[84:87], v212 offset:20480
    v_exp_f32 v28, v28
    v_exp_f32 v29, v29
    v_exp_f32 v30, v30
    v_exp_f32 v31, v31
    v_mfma_f32_32x32x8_bf16 v[216:231], v[140:141], v[94:95], v[216:231]
    ds_read_b64 v[92:93], v213 offset:21504
    v_exp_f32 v32, v32
    v_exp_f32 v33, v33
    v_exp_f32 v34, v34
    v_exp_f32 v35, v35
    v_smfmac_f32_32x32x32_bf16 v[60:75], v[180:183], v[20:27], v210
    s_add_u32 m0, s83, 34688
    s_add_u32 s74, s3, 61440
    buffer_load_dwordx4 v215, s[16:19], s74 offen lds
    v_exp_f32 v36, v36
    v_exp_f32 v37, v37
    v_exp_f32 v38, v38
    v_exp_f32 v39, v39
    v_smfmac_f32_32x32x32_bf16 v[60:75], v[184:187], v[28:35], v210
    v_exp_f32 v40, v40
    v_exp_f32 v41, v41
    v_exp_f32 v42, v42
    v_exp_f32 v43, v43
    v_mfma_f32_32x32x16_bf16 v[232:247], v[124:127], v[88:91], 0
    s_setprio 2
    v_exp_f32 v216, v216
    v_exp_f32 v217, v217
    v_exp_f32 v218, v218
    v_exp_f32 v219, v219
    v_mfma_f32_32x32x8_bf16 v[232:247], v[142:143], v[94:95], v[232:247]
    v_exp_f32 v220, v220
    v_exp_f32 v221, v221
    v_exp_f32 v222, v222
    v_exp_f32 v223, v223
    v_smfmac_f32_32x32x32_bf16 v[60:75], v[188:191], v[36:43], v210
    v_exp_f32 v224, v224
    v_exp_f32 v225, v225
    v_exp_f32 v226, v226
    v_exp_f32 v227, v227
    v_smfmac_f32_32x32x32_bf16 v[60:75], v[192:195], v[216:223], v210
    s_add_u32 m0, s83, 36608
    s_add_u32 s74, s3, 122880
    buffer_load_dwordx4 v215, s[16:19], s74 offen lds
    v_exp_f32 v228, v228
    v_exp_f32 v229, v229
    v_exp_f32 v230, v230
    v_exp_f32 v231, v231
    s_waitcnt lgkmcnt(0)
    v_mfma_f32_32x32x16_bf16 v[12:27], v[96:99], v[84:87], 0
    v_exp_f32 v232, v232
    v_exp_f32 v233, v233
    v_exp_f32 v234, v234
    v_exp_f32 v235, v235
    v_mfma_f32_32x32x8_bf16 v[12:27], v[128:129], v[92:93], v[12:27]
    v_exp_f32 v236, v236
    v_exp_f32 v237, v237
    v_exp_f32 v238, v238
    v_exp_f32 v239, v239
    v_smfmac_f32_32x32x32_bf16 v[60:75], v[196:199], v[224:231], v210
    v_exp_f32 v240, v240
    v_exp_f32 v241, v241
    v_exp_f32 v242, v242
    v_exp_f32 v243, v243
    v_smfmac_f32_32x32x32_bf16 v[60:75], v[200:203], v[232:239], v210
    v_exp_f32 v244, v244
    v_exp_f32 v245, v245
    v_exp_f32 v246, v246
    v_exp_f32 v247, v247
    v_mfma_f32_32x32x16_bf16 v[28:43], v[100:103], v[84:87], 0
    s_setprio 1
    v_exp_f32 v12, v12
    v_exp_f32 v13, v13
    v_exp_f32 v14, v14
    v_exp_f32 v15, v15
    v_mfma_f32_32x32x8_bf16 v[28:43], v[130:131], v[92:93], v[28:43]
    s_add_u32 m0, s83, 38528
    s_add_u32 s74, s3, 184320
    buffer_load_dwordx4 v215, s[16:19], s74 offen lds
    v_exp_f32 v16, v16
    v_exp_f32 v17, v17
    v_exp_f32 v18, v18
    v_exp_f32 v19, v19
    v_smfmac_f32_32x32x32_bf16 v[60:75], v[204:207], v[240:247], v210
    v_exp_f32 v20, v20
    v_exp_f32 v21, v21
    v_exp_f32 v22, v22
    v_exp_f32 v23, v23
    v_smfmac_f32_32x32x32_bf16 v[44:59], v[144:147], v[12:19], v210
    v_exp_f32 v24, v24
    v_exp_f32 v25, v25
    v_exp_f32 v26, v26
    v_exp_f32 v27, v27
    v_mfma_f32_32x32x16_bf16 v[216:231], v[104:107], v[84:87], 0
    v_exp_f32 v28, v28
    v_exp_f32 v29, v29
    v_exp_f32 v30, v30
    v_exp_f32 v31, v31
    v_mfma_f32_32x32x8_bf16 v[216:231], v[132:133], v[92:93], v[216:231]
    s_add_u32 m0, s83, 40448
    s_add_u32 s74, s3, 245760
    buffer_load_dwordx4 v215, s[16:19], s74 offen lds
    v_exp_f32 v32, v32
    v_exp_f32 v33, v33
    v_exp_f32 v34, v34
    v_exp_f32 v35, v35
    v_smfmac_f32_32x32x32_bf16 v[44:59], v[148:151], v[20:27], v210
    ds_write_b128 v211, v[60:63] offset:0
    v_exp_f32 v36, v36
    v_exp_f32 v37, v37
    v_exp_f32 v38, v38
    v_exp_f32 v39, v39
    v_smfmac_f32_32x32x32_bf16 v[44:59], v[152:155], v[28:35], v210
    ds_write_b128 v211, v[64:67] offset:1024
    v_exp_f32 v40, v40
    v_exp_f32 v41, v41
    v_exp_f32 v42, v42
    v_exp_f32 v43, v43
    v_mfma_f32_32x32x16_bf16 v[232:247], v[108:111], v[84:87], 0
    s_setprio 0
    v_exp_f32 v216, v216
    v_exp_f32 v217, v217
    v_exp_f32 v218, v218
    v_exp_f32 v219, v219
    v_mfma_f32_32x32x8_bf16 v[232:247], v[134:135], v[92:93], v[232:247]
    ds_write_b128 v211, v[68:71] offset:2048
    v_exp_f32 v220, v220
    v_exp_f32 v221, v221
    v_exp_f32 v222, v222
    v_exp_f32 v223, v223
    v_smfmac_f32_32x32x32_bf16 v[44:59], v[156:159], v[36:43], v210
    v_exp_f32 v224, v224
    v_exp_f32 v225, v225
    v_exp_f32 v226, v226
    v_exp_f32 v227, v227
    v_smfmac_f32_32x32x32_bf16 v[44:59], v[160:163], v[216:223], v210
    v_exp_f32 v228, v228
    v_exp_f32 v229, v229
    v_exp_f32 v230, v230
    v_exp_f32 v231, v231
    v_mfma_f32_32x32x16_bf16 v[12:27], v[112:115], v[84:87], 0
    v_add_u32 v212, s40, v4
    v_exp_f32 v232, v232
    v_exp_f32 v233, v233
    v_exp_f32 v234, v234
    v_exp_f32 v235, v235
    v_mfma_f32_32x32x8_bf16 v[12:27], v[136:137], v[92:93], v[12:27]
    v_add_u32 v211, s52, v214
    v_exp_f32 v236, v236
    v_exp_f32 v237, v237
    v_exp_f32 v238, v238
    v_exp_f32 v239, v239
    v_smfmac_f32_32x32x32_bf16 v[44:59], v[164:167], v[224:231], v210
    v_add_u32 v213, s40, v248
    v_exp_f32 v240, v240
    v_exp_f32 v241, v241
    v_exp_f32 v242, v242
    v_exp_f32 v243, v243
    v_smfmac_f32_32x32x32_bf16 v[44:59], v[168:171], v[232:239], v210
    v_exp_f32 v244, v244
    v_exp_f32 v245, v245
    v_exp_f32 v246, v246
    v_exp_f32 v247, v247
    s_waitcnt lgkmcnt(0)
    s_barrier
    v_mfma_f32_32x32x16_bf16 v[28:43], v[116:119], v[84:87], 0
    s_setprio 3
    v_exp_f32 v12, v12
    v_exp_f32 v13, v13
    v_exp_f32 v14, v14
    v_exp_f32 v15, v15
    v_mfma_f32_32x32x8_bf16 v[28:43], v[138:139], v[92:93], v[28:43]
    ds_read_b128 v[60:63], v211 offset:0
    v_exp_f32 v16, v16
    v_exp_f32 v17, v17
    v_exp_f32 v18, v18
    v_exp_f32 v19, v19
    v_smfmac_f32_32x32x32_bf16 v[44:59], v[172:175], v[240:247], v210
    ds_read_b128 v[64:67], v211 offset:1024
    v_exp_f32 v20, v20
    v_exp_f32 v21, v21
    v_exp_f32 v22, v22
    v_exp_f32 v23, v23
    v_smfmac_f32_32x32x32_bf16 v[44:59], v[176:179], v[12:19], v210
    ds_read_b128 v[68:71], v211 offset:2048
    v_exp_f32 v24, v24
    v_exp_f32 v25, v25
    v_exp_f32 v26, v26
    v_exp_f32 v27, v27
    v_mfma_f32_32x32x16_bf16 v[216:231], v[120:123], v[84:87], 0
    ds_read_b128 v[88:91], v212 offset:20480
    v_exp_f32 v28, v28
    v_exp_f32 v29, v29
    v_exp_f32 v30, v30
    v_exp_f32 v31, v31
    v_mfma_f32_32x32x8_bf16 v[216:231], v[140:141], v[92:93], v[216:231]
    ds_read_b64 v[94:95], v213 offset:21504
    v_exp_f32 v32, v32
    v_exp_f32 v33, v33
    v_exp_f32 v34, v34
    v_exp_f32 v35, v35
    v_smfmac_f32_32x32x32_bf16 v[44:59], v[180:183], v[20:27], v210
    s_add_u32 m0, s83, 42368
    s_add_u32 s74, s3, 307200
    buffer_load_dwordx4 v215, s[16:19], s74 offen lds
    v_exp_f32 v36, v36
    v_exp_f32 v37, v37
    v_exp_f32 v38, v38
    v_exp_f32 v39, v39
    v_smfmac_f32_32x32x32_bf16 v[44:59], v[184:187], v[28:35], v210
    v_exp_f32 v40, v40
    v_exp_f32 v41, v41
    v_exp_f32 v42, v42
    v_exp_f32 v43, v43
    v_mfma_f32_32x32x16_bf16 v[232:247], v[124:127], v[84:87], 0
    s_setprio 2
    v_exp_f32 v216, v216
    v_exp_f32 v217, v217
    v_exp_f32 v218, v218
    v_exp_f32 v219, v219
    v_mfma_f32_32x32x8_bf16 v[232:247], v[142:143], v[92:93], v[232:247]
    v_exp_f32 v220, v220
    v_exp_f32 v221, v221
    v_exp_f32 v222, v222
    v_exp_f32 v223, v223
    v_smfmac_f32_32x32x32_bf16 v[44:59], v[188:191], v[36:43], v210
    v_exp_f32 v224, v224
    v_exp_f32 v225, v225
    v_exp_f32 v226, v226
    v_exp_f32 v227, v227
    v_smfmac_f32_32x32x32_bf16 v[44:59], v[192:195], v[216:223], v210
    s_add_u32 m0, s83, 44288
    s_add_u32 s74, s3, 368640
    buffer_load_dwordx4 v215, s[16:19], s74 offen lds
    v_exp_f32 v228, v228
    v_exp_f32 v229, v229
    v_exp_f32 v230, v230
    v_exp_f32 v231, v231
    s_waitcnt lgkmcnt(0)
    v_mfma_f32_32x32x16_bf16 v[12:27], v[96:99], v[88:91], 0
    v_exp_f32 v232, v232
    v_exp_f32 v233, v233
    v_exp_f32 v234, v234
    v_exp_f32 v235, v235
    v_mfma_f32_32x32x8_bf16 v[12:27], v[128:129], v[94:95], v[12:27]
    v_exp_f32 v236, v236
    v_exp_f32 v237, v237
    v_exp_f32 v238, v238
    v_exp_f32 v239, v239
    v_smfmac_f32_32x32x32_bf16 v[44:59], v[196:199], v[224:231], v210
    v_exp_f32 v240, v240
    v_exp_f32 v241, v241
    v_exp_f32 v242, v242
    v_exp_f32 v243, v243
    v_smfmac_f32_32x32x32_bf16 v[44:59], v[200:203], v[232:239], v210
    v_exp_f32 v244, v244
    v_exp_f32 v245, v245
    v_exp_f32 v246, v246
    v_exp_f32 v247, v247
    v_mfma_f32_32x32x16_bf16 v[28:43], v[100:103], v[88:91], 0
    s_setprio 1
    v_exp_f32 v12, v12
    v_exp_f32 v13, v13
    v_exp_f32 v14, v14
    v_exp_f32 v15, v15
    v_mfma_f32_32x32x8_bf16 v[28:43], v[130:131], v[94:95], v[28:43]
    s_add_u32 m0, s83, 46208
    s_add_u32 s74, s3, 430080
    buffer_load_dwordx4 v215, s[16:19], s74 offen lds
    v_exp_f32 v16, v16
    v_exp_f32 v17, v17
    v_exp_f32 v18, v18
    v_exp_f32 v19, v19
    v_smfmac_f32_32x32x32_bf16 v[44:59], v[204:207], v[240:247], v210
    v_exp_f32 v20, v20
    v_exp_f32 v21, v21
    v_exp_f32 v22, v22
    v_exp_f32 v23, v23
    v_smfmac_f32_32x32x32_bf16 v[60:75], v[144:147], v[12:19], v210
    v_exp_f32 v24, v24
    v_exp_f32 v25, v25
    v_exp_f32 v26, v26
    v_exp_f32 v27, v27
    v_mfma_f32_32x32x16_bf16 v[216:231], v[104:107], v[88:91], 0
    v_exp_f32 v28, v28
    v_exp_f32 v29, v29
    v_exp_f32 v30, v30
    v_exp_f32 v31, v31
    v_mfma_f32_32x32x8_bf16 v[216:231], v[132:133], v[94:95], v[216:231]
    s_add_u32 m0, s83, 48128
    s_add_u32 s74, s3, 491520
    buffer_load_dwordx4 v215, s[16:19], s74 offen lds
    v_exp_f32 v32, v32
    v_exp_f32 v33, v33
    v_exp_f32 v34, v34
    v_exp_f32 v35, v35
    v_smfmac_f32_32x32x32_bf16 v[60:75], v[148:151], v[20:27], v210
    ds_write_b128 v211, v[44:47] offset:0
    v_exp_f32 v36, v36
    v_exp_f32 v37, v37
    v_exp_f32 v38, v38
    v_exp_f32 v39, v39
    v_smfmac_f32_32x32x32_bf16 v[60:75], v[152:155], v[28:35], v210
    ds_write_b128 v211, v[48:51] offset:1024
    v_exp_f32 v40, v40
    v_exp_f32 v41, v41
    v_exp_f32 v42, v42
    v_exp_f32 v43, v43
    v_mfma_f32_32x32x16_bf16 v[232:247], v[108:111], v[88:91], 0
    s_setprio 0
    v_exp_f32 v216, v216
    v_exp_f32 v217, v217
    v_exp_f32 v218, v218
    v_exp_f32 v219, v219
    v_mfma_f32_32x32x8_bf16 v[232:247], v[134:135], v[94:95], v[232:247]
    ds_write_b128 v211, v[52:55] offset:2048
    v_exp_f32 v220, v220
    v_exp_f32 v221, v221
    v_exp_f32 v222, v222
    v_exp_f32 v223, v223
    v_smfmac_f32_32x32x32_bf16 v[60:75], v[156:159], v[36:43], v210
    v_exp_f32 v224, v224
    v_exp_f32 v225, v225
    v_exp_f32 v226, v226
    v_exp_f32 v227, v227
    v_smfmac_f32_32x32x32_bf16 v[60:75], v[160:163], v[216:223], v210
    v_exp_f32 v228, v228
    v_exp_f32 v229, v229
    v_exp_f32 v230, v230
    v_exp_f32 v231, v231
    v_mfma_f32_32x32x16_bf16 v[12:27], v[112:115], v[88:91], 0
    v_add_u32 v212, s41, v4
    v_exp_f32 v232, v232
    v_exp_f32 v233, v233
    v_exp_f32 v234, v234
    v_exp_f32 v235, v235
    v_mfma_f32_32x32x8_bf16 v[12:27], v[136:137], v[94:95], v[12:27]
    v_add_u32 v211, s53, v214
    v_exp_f32 v236, v236
    v_exp_f32 v237, v237
    v_exp_f32 v238, v238
    v_exp_f32 v239, v239
    v_smfmac_f32_32x32x32_bf16 v[60:75], v[164:167], v[224:231], v210
    v_add_u32 v213, s41, v248
    v_exp_f32 v240, v240
    v_exp_f32 v241, v241
    v_exp_f32 v242, v242
    v_exp_f32 v243, v243
    v_smfmac_f32_32x32x32_bf16 v[60:75], v[168:171], v[232:239], v210
    v_exp_f32 v244, v244
    v_exp_f32 v245, v245
    v_exp_f32 v246, v246
    v_exp_f32 v247, v247
    s_waitcnt vmcnt(10) lgkmcnt(0)
    s_barrier
    v_mfma_f32_32x32x16_bf16 v[28:43], v[116:119], v[88:91], 0
    s_setprio 3
    v_exp_f32 v12, v12
    v_exp_f32 v13, v13
    v_exp_f32 v14, v14
    v_exp_f32 v15, v15
    v_mfma_f32_32x32x8_bf16 v[28:43], v[138:139], v[94:95], v[28:43]
    ds_read_b128 v[44:47], v211 offset:0
    v_exp_f32 v16, v16
    v_exp_f32 v17, v17
    v_exp_f32 v18, v18
    v_exp_f32 v19, v19
    v_smfmac_f32_32x32x32_bf16 v[60:75], v[172:175], v[240:247], v210
    ds_read_b128 v[48:51], v211 offset:1024
    v_exp_f32 v20, v20
    v_exp_f32 v21, v21
    v_exp_f32 v22, v22
    v_exp_f32 v23, v23
    v_smfmac_f32_32x32x32_bf16 v[60:75], v[176:179], v[12:19], v210
    ds_read_b128 v[52:55], v211 offset:2048
    v_exp_f32 v24, v24
    v_exp_f32 v25, v25
    v_exp_f32 v26, v26
    v_exp_f32 v27, v27
    v_mfma_f32_32x32x16_bf16 v[216:231], v[120:123], v[88:91], 0
    ds_read_b128 v[84:87], v212 offset:20480
    v_exp_f32 v28, v28
    v_exp_f32 v29, v29
    v_exp_f32 v30, v30
    v_exp_f32 v31, v31
    v_mfma_f32_32x32x8_bf16 v[216:231], v[140:141], v[94:95], v[216:231]
    ds_read_b64 v[92:93], v213 offset:21504
    v_exp_f32 v32, v32
    v_exp_f32 v33, v33
    v_exp_f32 v34, v34
    v_exp_f32 v35, v35
    v_smfmac_f32_32x32x32_bf16 v[60:75], v[180:183], v[20:27], v210
    s_add_u32 m0, s83, 50048
    s_add_u32 s74, s3, 552960
    buffer_load_dwordx4 v215, s[16:19], s74 offen lds
    v_exp_f32 v36, v36
    v_exp_f32 v37, v37
    v_exp_f32 v38, v38
    v_exp_f32 v39, v39
    v_smfmac_f32_32x32x32_bf16 v[60:75], v[184:187], v[28:35], v210
    v_exp_f32 v40, v40
    v_exp_f32 v41, v41
    v_exp_f32 v42, v42
    v_exp_f32 v43, v43
    v_mfma_f32_32x32x16_bf16 v[232:247], v[124:127], v[88:91], 0
    s_setprio 2
    v_exp_f32 v216, v216
    v_exp_f32 v217, v217
    v_exp_f32 v218, v218
    v_exp_f32 v219, v219
    v_mfma_f32_32x32x8_bf16 v[232:247], v[142:143], v[94:95], v[232:247]
    v_exp_f32 v220, v220
    v_exp_f32 v221, v221
    v_exp_f32 v222, v222
    v_exp_f32 v223, v223
    v_smfmac_f32_32x32x32_bf16 v[60:75], v[188:191], v[36:43], v210
    v_exp_f32 v224, v224
    v_exp_f32 v225, v225
    v_exp_f32 v226, v226
    v_exp_f32 v227, v227
    v_smfmac_f32_32x32x32_bf16 v[60:75], v[192:195], v[216:223], v210
    s_cmp_eq_u32 s68, 0
    s_cbranch_scc1 L_fy
L_nofy:
    v_exp_f32 v228, v228
    v_exp_f32 v229, v229
    v_exp_f32 v230, v230
    v_exp_f32 v231, v231
    s_waitcnt lgkmcnt(0)
    v_mfma_f32_32x32x16_bf16 v[12:27], v[96:99], v[84:87], 0
    v_exp_f32 v232, v232
    v_exp_f32 v233, v233
    v_exp_f32 v234, v234
    v_exp_f32 v235, v235
    v_mfma_f32_32x32x8_bf16 v[12:27], v[128:129], v[92:93], v[12:27]
    v_exp_f32 v236, v236
    v_exp_f32 v237, v237
    v_exp_f32 v238, v238
    v_exp_f32 v239, v239
    v_smfmac_f32_32x32x32_bf16 v[60:75], v[196:199], v[224:231], v210
    v_exp_f32 v240, v240
    v_exp_f32 v241, v241
    v_exp_f32 v242, v242
    v_exp_f32 v243, v243
    v_smfmac_f32_32x32x32_bf16 v[60:75], v[200:203], v[232:239], v210
    v_exp_f32 v244, v244
    v_exp_f32 v245, v245
    v_exp_f32 v246, v246
    v_exp_f32 v247, v247
    v_mfma_f32_32x32x16_bf16 v[28:43], v[100:103], v[84:87], 0
    s_setprio 1
    v_exp_f32 v12, v12
    v_exp_f32 v13, v13
    v_exp_f32 v14, v14
    v_exp_f32 v15, v15
    v_mfma_f32_32x32x8_bf16 v[28:43], v[130:131], v[92:93], v[28:43]
    s_add_u32 m0, s83, 51968
    s_add_u32 s74, s3, 614400
    buffer_load_dwordx4 v215, s[16:19], s74 offen lds
    v_exp_f32 v16, v16
    v_exp_f32 v17, v17
    v_exp_f32 v18, v18
    v_exp_f32 v19, v19
    v_smfmac_f32_32x32x32_bf16 v[60:75], v[204:207], v[240:247], v210
    v_exp_f32 v20, v20
    v_exp_f32 v21, v21
    v_exp_f32 v22, v22
    v_exp_f32 v23, v23
    v_smfmac_f32_32x32x32_bf16 v[44:59], v[144:147], v[12:19], v210
    v_exp_f32 v24, v24
    v_exp_f32 v25, v25
    v_exp_f32 v26, v26
    v_exp_f32 v27, v27
    v_mfma_f32_32x32x16_bf16 v[216:231], v[104:107], v[84:87], 0
    v_exp_f32 v28, v28
    v_exp_f32 v29, v29
    v_exp_f32 v30, v30
    v_exp_f32 v31, v31
    v_mfma_f32_32x32x8_bf16 v[216:231], v[132:133], v[92:93], v[216:231]
    s_add_u32 m0, s83, 53888
    s_add_u32 s74, s3, 675840
    buffer_load_dwordx4 v215, s[16:19], s74 offen lds
    v_exp_f32 v32, v32
    v_exp_f32 v33, v33
    v_exp_f32 v34, v34
    v_exp_f32 v35, v35
    v_smfmac_f32_32x32x32_bf16 v[44:59], v[148:151], v[20:27], v210
    ds_write_b128 v211, v[60:63] offset:0
    v_exp_f32 v36, v36
    v_exp_f32 v37, v37
    v_exp_f32 v38, v38
    v_exp_f32 v39, v39
    v_smfmac_f32_32x32x32_bf16 v[44:59], v[152:155], v[28:35], v210
    ds_write_b128 v211, v[64:67] offset:1024
    v_exp_f32 v40, v40
    v_exp_f32 v41, v41
    v_exp_f32 v42, v42
    v_exp_f32 v43, v43
    v_mfma_f32_32x32x16_bf16 v[232:247], v[108:111], v[84:87], 0
    s_setprio 0
    v_exp_f32 v216, v216
    v_exp_f32 v217, v217
    v_exp_f32 v218, v218
    v_exp_f32 v219, v219
    v_mfma_f32_32x32x8_bf16 v[232:247], v[134:135], v[92:93], v[232:247]
    ds_write_b128 v211, v[68:71] offset:2048
    v_exp_f32 v220, v220
    v_exp_f32 v221, v221
    v_exp_f32 v222, v222
    v_exp_f32 v223, v223
    v_smfmac_f32_32x32x32_bf16 v[44:59], v[156:159], v[36:43], v210
    v_exp_f32 v224, v224
    v_exp_f32 v225, v225
    v_exp_f32 v226, v226
    v_exp_f32 v227, v227
    v_smfmac_f32_32x32x32_bf16 v[44:59], v[160:163], v[216:223], v210
    v_exp_f32 v228, v228
    v_exp_f32 v229, v229
    v_exp_f32 v230, v230
    v_exp_f32 v231, v231
    v_mfma_f32_32x32x16_bf16 v[12:27], v[112:115], v[84:87], 0
    v_add_u32 v212, s42, v4
    v_exp_f32 v232, v232
    v_exp_f32 v233, v233
    v_exp_f32 v234, v234
    v_exp_f32 v235, v235
    v_mfma_f32_32x32x8_bf16 v[12:27], v[136:137], v[92:93], v[12:27]
    v_add_u32 v211, s54, v214
    v_exp_f32 v236, v236
    v_exp_f32 v237, v237
    v_exp_f32 v238, v238
    v_exp_f32 v239, v239
    v_smfmac_f32_32x32x32_bf16 v[44:59], v[164:167], v[224:231], v210
    v_add_u32 v213, s42, v248
    v_exp_f32 v240, v240
    v_exp_f32 v241, v241
    v_exp_f32 v242, v242
    v_exp_f32 v243, v243
    v_smfmac_f32_32x32x32_bf16 v[44:59], v[168:171], v[232:239], v210
    v_exp_f32 v244, v244
    v_exp_f32 v245, v245
    v_exp_f32 v246, v246
    v_exp_f32 v247, v247
    s_waitcnt lgkmcnt(0)
    s_barrier
    v_mfma_f32_32x32x16_bf16 v[28:43], v[116:119], v[84:87], 0
    s_setprio 3
    v_exp_f32 v12, v12
    v_exp_f32 v13, v13
    v_exp_f32 v14, v14
    v_exp_f32 v15, v15
    v_mfma_f32_32x32x8_bf16 v[28:43], v[138:139], v[92:93], v[28:43]
    ds_read_b128 v[60:63], v211 offset:0
    v_exp_f32 v16, v16
    v_exp_f32 v17, v17
    v_exp_f32 v18, v18
    v_exp_f32 v19, v19
    v_smfmac_f32_32x32x32_bf16 v[44:59], v[172:175], v[240:247], v210
    ds_read_b128 v[64:67], v211 offset:1024
    v_exp_f32 v20, v20
    v_exp_f32 v21, v21
    v_exp_f32 v22, v22
    v_exp_f32 v23, v23
    v_smfmac_f32_32x32x32_bf16 v[44:59], v[176:179], v[12:19], v210
    ds_read_b128 v[68:71], v211 offset:2048
    v_exp_f32 v24, v24
    v_exp_f32 v25, v25
    v_exp_f32 v26, v26
    v_exp_f32 v27, v27
    v_mfma_f32_32x32x16_bf16 v[216:231], v[120:123], v[84:87], 0
    ds_read_b128 v[88:91], v212 offset:20480
    v_exp_f32 v28, v28
    v_exp_f32 v29, v29
    v_exp_f32 v30, v30
    v_exp_f32 v31, v31
    v_mfma_f32_32x32x8_bf16 v[216:231], v[140:141], v[92:93], v[216:231]
    ds_read_b64 v[94:95], v213 offset:21504
    v_exp_f32 v32, v32
    v_exp_f32 v33, v33
    v_exp_f32 v34, v34
    v_exp_f32 v35, v35
    v_smfmac_f32_32x32x32_bf16 v[44:59], v[180:183], v[20:27], v210
    s_add_u32 m0, s83, 55808
    s_add_u32 s74, s3, 737280
    buffer_load_dwordx4 v215, s[16:19], s74 offen lds
    v_exp_f32 v36, v36
    v_exp_f32 v37, v37
    v_exp_f32 v38, v38
    v_exp_f32 v39, v39
    v_smfmac_f32_32x32x32_bf16 v[44:59], v[184:187], v[28:35], v210
    v_exp_f32 v40, v40
    v_exp_f32 v41, v41
    v_exp_f32 v42, v42
    v_exp_f32 v43, v43
    v_mfma_f32_32x32x16_bf16 v[232:247], v[124:127], v[84:87], 0
    s_setprio 2
    v_exp_f32 v216, v216
    v_exp_f32 v217, v217
    v_exp_f32 v218, v218
    v_exp_f32 v219, v219
    v_mfma_f32_32x32x8_bf16 v[232:247], v[142:143], v[92:93], v[232:247]
    v_exp_f32 v220, v220
    v_exp_f32 v221, v221
    v_exp_f32 v222, v222
    v_exp_f32 v223, v223
    v_smfmac_f32_32x32x32_bf16 v[44:59], v[188:191], v[36:43], v210
    v_exp_f32 v224, v224
    v_exp_f32 v225, v225
    v_exp_f32 v226, v226
    v_exp_f32 v227, v227
    v_smfmac_f32_32x32x32_bf16 v[44:59], v[192:195], v[216:223], v210
    s_cmp_ge_u32 s68, 4
    s_cbranch_scc1 L_wo13
    s_add_u32 m0, s83, 57728
    s_add_u32 s74, s3, 798720
    buffer_load_dwordx4 v215, s[16:19], s74 offen lds
L_wo13:
    v_exp_f32 v228, v228
    v_exp_f32 v229, v229
    v_exp_f32 v230, v230
    v_exp_f32 v231, v231
    s_waitcnt lgkmcnt(0)
    v_mfma_f32_32x32x16_bf16 v[12:27], v[96:99], v[88:91], 0
    v_exp_f32 v232, v232
    v_exp_f32 v233, v233
    v_exp_f32 v234, v234
    v_exp_f32 v235, v235
    v_mfma_f32_32x32x8_bf16 v[12:27], v[128:129], v[94:95], v[12:27]
    v_exp_f32 v236, v236
    v_exp_f32 v237, v237
    v_exp_f32 v238, v238
    v_exp_f32 v239, v239
    v_smfmac_f32_32x32x32_bf16 v[44:59], v[196:199], v[224:231], v210
    v_exp_f32 v240, v240
    v_exp_f32 v241, v241
    v_exp_f32 v242, v242
    v_exp_f32 v243, v243
    v_smfmac_f32_32x32x32_bf16 v[44:59], v[200:203], v[232:239], v210
    v_exp_f32 v244, v244
    v_exp_f32 v245, v245
    v_exp_f32 v246, v246
    v_exp_f32 v247, v247
    v_mfma_f32_32x32x16_bf16 v[28:43], v[100:103], v[88:91], 0
    s_setprio 1
    v_exp_f32 v12, v12
    v_exp_f32 v13, v13
    v_exp_f32 v14, v14
    v_exp_f32 v15, v15
    v_mfma_f32_32x32x8_bf16 v[28:43], v[130:131], v[94:95], v[28:43]
    s_lshl_b32 s84, s69, 3
    s_add_u32 s84, s84, s70
    v_exp_f32 v16, v16
    v_exp_f32 v17, v17
    v_exp_f32 v18, v18
    v_exp_f32 v19, v19
    v_smfmac_f32_32x32x32_bf16 v[44:59], v[204:207], v[240:247], v210
    s_mov_b32 s24, s62
    s_and_b32 s25, s63, 0xffff
    v_exp_f32 v20, v20
    v_exp_f32 v21, v21
    v_exp_f32 v22, v22
    v_exp_f32 v23, v23
    v_smfmac_f32_32x32x32_bf16 v[60:75], v[144:147], v[12:19], v210
    s_mov_b32 s26, 0x280000
    s_mov_b32 s27, 0x00020000
    v_exp_f32 v24, v24
    v_exp_f32 v25, v25
    v_exp_f32 v26, v26
    v_exp_f32 v27, v27
    v_mfma_f32_32x32x16_bf16 v[216:231], v[104:107], v[88:91], 0
    s_lshr_b32 s85, s68, 1
    s_mul_i32 s73, s70, 160
    v_exp_f32 v28, v28
    v_exp_f32 v29, v29
    v_exp_f32 v30, v30
    v_exp_f32 v31, v31
    v_mfma_f32_32x32x8_bf16 v[216:231], v[132:133], v[94:95], v[216:231]
    s_lshl_b32 s72, s85, 6
    s_add_u32 s77, s77, s73
    v_exp_f32 v32, v32
    v_exp_f32 v33, v33
    v_exp_f32 v34, v34
    v_exp_f32 v35, v35
    v_smfmac_f32_32x32x32_bf16 v[60:75], v[148:151], v[20:27], v210
    ds_write_b128 v211, v[44:47] offset:0
    v_exp_f32 v36, v36
    v_exp_f32 v37, v37
    v_exp_f32 v38, v38
    v_exp_f32 v39, v39
    v_smfmac_f32_32x32x32_bf16 v[60:75], v[152:155], v[28:35], v210
    ds_write_b128 v211, v[48:51] offset:1024
    v_exp_f32 v40, v40
    v_exp_f32 v41, v41
    v_exp_f32 v42, v42
    v_exp_f32 v43, v43
    v_mfma_f32_32x32x16_bf16 v[232:247], v[108:111], v[88:91], 0
    s_setprio 0
    v_exp_f32 v216, v216
    v_exp_f32 v217, v217
    v_exp_f32 v218, v218
    v_exp_f32 v219, v219
    v_mfma_f32_32x32x8_bf16 v[232:247], v[134:135], v[94:95], v[232:247]
    ds_write_b128 v211, v[52:55] offset:2048
    v_exp_f32 v220, v220
    v_exp_f32 v221, v221
    v_exp_f32 v222, v222
    v_exp_f32 v223, v223
    v_smfmac_f32_32x32x32_bf16 v[60:75], v[156:159], v[36:43], v210
    s_add_u32 s77, s77, s72
    s_mul_i32 s81, s73, 2112
    v_exp_f32 v224, v224
    v_exp_f32 v225, v225
    v_exp_f32 v226, v226
    v_exp_f32 v227, v227
    v_smfmac_f32_32x32x32_bf16 v[60:75], v[160:163], v[216:223], v210
    s_lshl_b32 s73, s69, 7
    s_add_u32 s81, s81, s73
    v_exp_f32 v228, v228
    v_exp_f32 v229, v229
    v_exp_f32 v230, v230
    v_exp_f32 v231, v231
    v_mfma_f32_32x32x16_bf16 v[12:27], v[112:115], v[88:91], 0
    v_add_u32 v212, s43, v4
    v_exp_f32 v232, v232
    v_exp_f32 v233, v233
    v_exp_f32 v234, v234
    v_exp_f32 v235, v235
    v_mfma_f32_32x32x8_bf16 v[12:27], v[136:137], v[94:95], v[12:27]
    v_add_u32 v211, s55, v214
    v_exp_f32 v236, v236
    v_exp_f32 v237, v237
    v_exp_f32 v238, v238
    v_exp_f32 v239, v239
    v_smfmac_f32_32x32x32_bf16 v[60:75], v[164:167], v[224:231], v210
    v_add_u32 v213, s43, v248
    v_exp_f32 v240, v240
    v_exp_f32 v241, v241
    v_exp_f32 v242, v242
    v_exp_f32 v243, v243
    v_smfmac_f32_32x32x32_bf16 v[60:75], v[168:171], v[232:239], v210
    s_add_u32 s81, s81, 0x800000
    s_mul_i32 s73, s68, 33792
    v_exp_f32 v244, v244
    v_exp_f32 v245, v245
    v_exp_f32 v246, v246
    v_exp_f32 v247, v247
    s_waitcnt lgkmcnt(0)
    s_barrier
    v_mfma_f32_32x32x16_bf16 v[28:43], v[116:119], v[88:91], 0
    s_setprio 3
    v_exp_f32 v12, v12
    v_exp_f32 v13, v13
    v_exp_f32 v14, v14
    v_exp_f32 v15, v15
    v_mfma_f32_32x32x8_bf16 v[28:43], v[138:139], v[94:95], v[28:43]
    ds_read_b128 v[44:47], v211 offset:0
    v_exp_f32 v16, v16
    v_exp_f32 v17, v17
    v_exp_f32 v18, v18
    v_exp_f32 v19, v19
    v_smfmac_f32_32x32x32_bf16 v[60:75], v[172:175], v[240:247], v210
    ds_read_b128 v[48:51], v211 offset:1024
    v_exp_f32 v20, v20
    v_exp_f32 v21, v21
    v_exp_f32 v22, v22
    v_exp_f32 v23, v23
    v_smfmac_f32_32x32x32_bf16 v[60:75], v[176:179], v[12:19], v210
    ds_read_b128 v[52:55], v211 offset:2048
    v_exp_f32 v24, v24
    v_exp_f32 v25, v25
    v_exp_f32 v26, v26
    v_exp_f32 v27, v27
    v_mfma_f32_32x32x16_bf16 v[216:231], v[120:123], v[88:91], 0
    ds_read_b128 v[84:87], v212 offset:20480
    v_exp_f32 v28, v28
    v_exp_f32 v29, v29
    v_exp_f32 v30, v30
    v_exp_f32 v31, v31
    v_mfma_f32_32x32x8_bf16 v[216:231], v[140:141], v[94:95], v[216:231]
    ds_read_b64 v[92:93], v213 offset:21504
    v_exp_f32 v32, v32
    v_exp_f32 v33, v33
    v_exp_f32 v34, v34
    v_exp_f32 v35, v35
    v_smfmac_f32_32x32x32_bf16 v[60:75], v[180:183], v[20:27], v210
    s_add_u32 s81, s81, s73
    v_exp_f32 v36, v36
    v_exp_f32 v37, v37
    v_exp_f32 v38, v38
    v_exp_f32 v39, v39
    v_smfmac_f32_32x32x32_bf16 v[60:75], v[184:187], v[28:35], v210
    s_add_u32 s93, s68, 7
    s_and_b32 s93, s93, 7
    v_exp_f32 v40, v40
    v_exp_f32 v41, v41
    v_exp_f32 v42, v42
    v_exp_f32 v43, v43
    v_mfma_f32_32x32x16_bf16 v[232:247], v[124:127], v[88:91], 0
    s_setprio 2
    v_exp_f32 v216, v216
    v_exp_f32 v217, v217
    v_exp_f32 v218, v218
    v_exp_f32 v219, v219
    v_mfma_f32_32x32x8_bf16 v[232:247], v[142:143], v[94:95], v[232:247]
    s_lshl_b32 s46, s84, 1
    s_and_b32 s73, s93, 1
    v_exp_f32 v220, v220
    v_exp_f32 v221, v221
    v_exp_f32 v222, v222
    v_exp_f32 v223, v223
    v_smfmac_f32_32x32x32_bf16 v[60:75], v[188:191], v[36:43], v210
    s_add_u32 s46, s46, s73
    s_mul_i32 s46, s46, 5120
    v_exp_f32 v224, v224
    v_exp_f32 v225, v225
    v_exp_f32 v226, v226
    v_exp_f32 v227, v227
    v_smfmac_f32_32x32x32_bf16 v[60:75], v[192:195], v[216:223], v210
    s_lshr_b32 s73, s93, 1
    s_lshl_b32 s45, s73, 10
    v_exp_f32 v228, v228
    v_exp_f32 v229, v229
    v_exp_f32 v230, v230
    v_exp_f32 v231, v231
    s_waitcnt lgkmcnt(0)
    v_mfma_f32_32x32x16_bf16 v[12:27], v[96:99], v[84:87], 0
    s_add_u32 s45, s45, s46
    s_lshl_b32 s73, s73, 8
    v_exp_f32 v232, v232
    v_exp_f32 v233, v233
    v_exp_f32 v234, v234
    v_exp_f32 v235, v235
    v_mfma_f32_32x32x8_bf16 v[12:27], v[128:129], v[92:93], v[12:27]
    s_add_u32 s46, s46, s73
    s_add_u32 s46, s46, 4096
    v_exp_f32 v236, v236
    v_exp_f32 v237, v237
    v_exp_f32 v238, v238
    v_exp_f32 v239, v239
    v_smfmac_f32_32x32x32_bf16 v[60:75], v[196:199], v[224:231], v210
    v_exp_f32 v240, v240
    v_exp_f32 v241, v241
    v_exp_f32 v242, v242
    v_exp_f32 v243, v243
    v_smfmac_f32_32x32x32_bf16 v[60:75], v[200:203], v[232:239], v210
    v_exp_f32 v244, v244
    v_exp_f32 v245, v245
    v_exp_f32 v246, v246
    v_exp_f32 v247, v247
    v_mfma_f32_32x32x16_bf16 v[28:43], v[100:103], v[84:87], 0
    s_setprio 1
    v_exp_f32 v12, v12
    v_exp_f32 v13, v13
    v_exp_f32 v14, v14
    v_exp_f32 v15, v15
    v_mfma_f32_32x32x8_bf16 v[28:43], v[130:131], v[92:93], v[28:43]
    s_lshl_b32 s72, s70, 12
    s_add_u32 s72, s72, 0xd0c000
    v_exp_f32 v16, v16
    v_exp_f32 v17, v17
    v_exp_f32 v18, v18
    v_exp_f32 v19, v19
    v_smfmac_f32_32x32x32_bf16 v[60:75], v[204:207], v[240:247], v210
    v_lshl_add_u32 v9, v2, 7, s72
    buffer_load_dword v76, v9, s[8:11], 0 offen sc1
    v_exp_f32 v20, v20
    v_exp_f32 v21, v21
    v_exp_f32 v22, v22
    v_exp_f32 v23, v23
    v_smfmac_f32_32x32x32_bf16 v[44:59], v[144:147], v[12:19], v210
    v_lshrrev_b32 v5, 3, v1
    v_mul_u32_u24 v5, 4096, v5
    v_exp_f32 v24, v24
    v_exp_f32 v25, v25
    v_exp_f32 v26, v26
    v_exp_f32 v27, v27
    v_mfma_f32_32x32x16_bf16 v[216:231], v[104:107], v[84:87], 0
    v_add_u32 v5, v5, v4
    s_lshl_b32 s72, s68, 10
    v_exp_f32 v28, v28
    v_exp_f32 v29, v29
    v_exp_f32 v30, v30
    v_exp_f32 v31, v31
    v_mfma_f32_32x32x8_bf16 v[216:231], v[132:133], v[92:93], v[216:231]
    s_min_u32 s7, s85, 2
    v_exp_f32 v32, v32
    v_exp_f32 v33, v33
    v_exp_f32 v34, v34
    v_exp_f32 v35, v35
    v_smfmac_f32_32x32x32_bf16 v[44:59], v[148:151], v[20:27], v210
    ds_write_b128 v211, v[60:63] offset:0
    v_exp_f32 v36, v36
    v_exp_f32 v37, v37
    v_exp_f32 v38, v38
    v_exp_f32 v39, v39
    v_smfmac_f32_32x32x32_bf16 v[44:59], v[152:155], v[28:35], v210
    ds_write_b128 v211, v[64:67] offset:1024
    v_exp_f32 v40, v40
    v_exp_f32 v41, v41
    v_exp_f32 v42, v42
    v_exp_f32 v43, v43
    v_mfma_f32_32x32x16_bf16 v[232:247], v[108:111], v[84:87], 0
    s_setprio 0
    v_exp_f32 v216, v216
    v_exp_f32 v217, v217
    v_exp_f32 v218, v218
    v_exp_f32 v219, v219
    v_mfma_f32_32x32x8_bf16 v[232:247], v[134:135], v[92:93], v[232:247]
    ds_write_b128 v211, v[68:71] offset:2048
    v_exp_f32 v220, v220
    v_exp_f32 v221, v221
    v_exp_f32 v222, v222
    v_exp_f32 v223, v223
    v_smfmac_f32_32x32x32_bf16 v[44:59], v[156:159], v[36:43], v210
    s_cmp_eq_u32 s85, 3
    s_cselect_b32 s3, 1, 0
    v_exp_f32 v224, v224
    v_exp_f32 v225, v225
    v_exp_f32 v226, v226
    v_exp_f32 v227, v227
    v_smfmac_f32_32x32x32_bf16 v[44:59], v[160:163], v[216:223], v210
    s_cmp_ge_u32 s85, 2
    s_cselect_b32 s80, 2, 1
    v_exp_f32 v228, v228
    v_exp_f32 v229, v229
    v_exp_f32 v230, v230
    v_exp_f32 v231, v231
    v_mfma_f32_32x32x16_bf16 v[12:27], v[112:115], v[84:87], 0
    v_add_u32 v212, s44, v4
    v_exp_f32 v232, v232
    v_exp_f32 v233, v233
    v_exp_f32 v234, v234
    v_exp_f32 v235, v235
    v_mfma_f32_32x32x8_bf16 v[12:27], v[136:137], v[92:93], v[12:27]
    v_add_u32 v211, s56, v214
    v_exp_f32 v236, v236
    v_exp_f32 v237, v237
    v_exp_f32 v238, v238
    v_exp_f32 v239, v239
    v_smfmac_f32_32x32x32_bf16 v[44:59], v[164:167], v[224:231], v210
    v_add_u32 v213, s44, v248
    v_exp_f32 v240, v240
    v_exp_f32 v241, v241
    v_exp_f32 v242, v242
    v_exp_f32 v243, v243
    v_smfmac_f32_32x32x32_bf16 v[44:59], v[168:171], v[232:239], v210
    v_bfe_u32 v209, v1, 2, 2
    v_mul_u32_u24 v209, 26176, v209
    v_exp_f32 v244, v244
    v_exp_f32 v245, v245
    v_exp_f32 v246, v246
    v_exp_f32 v247, v247
    s_waitcnt vmcnt(1) lgkmcnt(0)
    s_barrier
    v_mfma_f32_32x32x16_bf16 v[28:43], v[116:119], v[84:87], 0
    s_setprio 3
    v_exp_f32 v12, v12
    v_exp_f32 v13, v13
    v_exp_f32 v14, v14
    v_exp_f32 v15, v15
    v_mfma_f32_32x32x8_bf16 v[28:43], v[138:139], v[92:93], v[28:43]
    ds_read_b128 v[60:63], v211 offset:0
    v_exp_f32 v16, v16
    v_exp_f32 v17, v17
    v_exp_f32 v18, v18
    v_exp_f32 v19, v19
    v_smfmac_f32_32x32x32_bf16 v[44:59], v[172:175], v[240:247], v210
    ds_read_b128 v[64:67], v211 offset:1024
    v_exp_f32 v20, v20
    v_exp_f32 v21, v21
    v_exp_f32 v22, v22
    v_exp_f32 v23, v23
    v_smfmac_f32_32x32x32_bf16 v[44:59], v[176:179], v[12:19], v210
    ds_read_b128 v[68:71], v211 offset:2048
    v_exp_f32 v24, v24
    v_exp_f32 v25, v25
    v_exp_f32 v26, v26
    v_exp_f32 v27, v27
    v_mfma_f32_32x32x16_bf16 v[216:231], v[120:123], v[84:87], 0
    ds_read_b128 v[88:91], v212 offset:20480
    v_exp_f32 v28, v28
    v_exp_f32 v29, v29
    v_exp_f32 v30, v30
    v_exp_f32 v31, v31
    v_mfma_f32_32x32x8_bf16 v[216:231], v[140:141], v[92:93], v[216:231]
    ds_read_b64 v[94:95], v213 offset:21504
    v_exp_f32 v32, v32
    v_exp_f32 v33, v33
    v_exp_f32 v34, v34
    v_exp_f32 v35, v35
    v_smfmac_f32_32x32x32_bf16 v[44:59], v[180:183], v[20:27], v210
    v_and_b32 v6, 3, v1
    v_lshl_add_u32 v209, v6, 3, v209
    v_exp_f32 v36, v36
    v_exp_f32 v37, v37
    v_exp_f32 v38, v38
    v_exp_f32 v39, v39
    v_smfmac_f32_32x32x32_bf16 v[44:59], v[184:187], v[28:35], v210
    v_bfe_u32 v6, v1, 4, 1
    v_lshl_add_u32 v209, v6, 5, v209
    v_exp_f32 v40, v40
    v_exp_f32 v41, v41
    v_exp_f32 v42, v42
    v_exp_f32 v43, v43
    v_mfma_f32_32x32x16_bf16 v[232:247], v[124:127], v[84:87], 0
    s_setprio 2
    v_exp_f32 v216, v216
    v_exp_f32 v217, v217
    v_exp_f32 v218, v218
    v_exp_f32 v219, v219
    v_mfma_f32_32x32x8_bf16 v[232:247], v[142:143], v[92:93], v[232:247]
    s_lshl_b32 s73, s7, 6
    s_add_u32 s73, s73, 32768
    v_exp_f32 v220, v220
    v_exp_f32 v221, v221
    v_exp_f32 v222, v222
    v_exp_f32 v223, v223
    v_smfmac_f32_32x32x32_bf16 v[44:59], v[188:191], v[36:43], v210
    v_add_u32 v209, s73, v209
    v_mul_u32_u24 v6, 160, v3
    v_exp_f32 v224, v224
    v_exp_f32 v225, v225
    v_exp_f32 v226, v226
    v_exp_f32 v227, v227
    v_smfmac_f32_32x32x32_bf16 v[44:59], v[192:195], v[216:223], v210
    v_add_u32 v208, v209, v6
    v_mul_u32_u24 v6, 1600, v3
    v_add_u32 v209, v209, v6
    s_add_u32 s76, s70, s3
    s_waitcnt vmcnt(0)
    v_exp_f32 v228, v228
    v_exp_f32 v229, v229
    v_exp_f32 v230, v230
    v_exp_f32 v231, v231
    s_waitcnt lgkmcnt(0)
    v_mfma_f32_32x32x16_bf16 v[12:27], v[96:99], v[88:91], 0
    v_cmp_ne_u32 vcc, s71, v76
    v_exp_f32 v232, v232
    v_exp_f32 v233, v233
    v_exp_f32 v234, v234
    v_exp_f32 v235, v235
    v_mfma_f32_32x32x8_bf16 v[12:27], v[128:129], v[94:95], v[12:27]
    v_exp_f32 v236, v236
    v_exp_f32 v237, v237
    v_exp_f32 v238, v238
    v_exp_f32 v239, v239
    v_smfmac_f32_32x32x32_bf16 v[44:59], v[196:199], v[224:231], v210
    s_cbranch_vccnz L_py_retry0
L_py_back:
    s_add_u32 m0, s72, 10240
    s_cmp_ge_u32 s68, 6
    buffer_load_dwordx4 v5, s[8:11], s81 offen sc1 lds
    s_cbranch_scc1 L_y2
L_y2_e:
    v_exp_f32 v240, v240
    v_exp_f32 v241, v241
    v_exp_f32 v242, v242
    v_exp_f32 v243, v243
    v_smfmac_f32_32x32x32_bf16 v[44:59], v[200:203], v[232:239], v210
    v_exp_f32 v244, v244
    v_exp_f32 v245, v245
    v_exp_f32 v246, v246
    v_exp_f32 v247, v247
    v_mfma_f32_32x32x16_bf16 v[28:43], v[100:103], v[88:91], 0
    s_setprio 1
    s_and_b32 s76, s76, 7
    s_mul_i32 s74, s76, 3200
    v_add_u32 v212, s74, v208
    v_add_u32 v213, s74, v209
    s_add_u32 s76, s76, s80
    ds_read_b64_tr_b16 v[96:97], v212 offset:0
    ds_read_b64_tr_b16 v[98:99], v212 offset:320
    v_exp_f32 v12, v12
    v_exp_f32 v13, v13
    v_exp_f32 v14, v14
    v_exp_f32 v15, v15
    v_mfma_f32_32x32x8_bf16 v[28:43], v[130:131], v[94:95], v[28:43]
    ds_read_b64_tr_b16 v[84:85], v212 offset:800
    ds_read_b64_tr_b16 v[86:87], v212 offset:1120
    v_exp_f32 v16, v16
    v_exp_f32 v17, v17
    v_exp_f32 v18, v18
    v_exp_f32 v19, v19
    v_smfmac_f32_32x32x32_bf16 v[44:59], v[204:207], v[240:247], v210
    ds_read_b64_tr_b16 v[76:77], v212 offset:1600
    ds_read_b64_tr_b16 v[78:79], v212 offset:1920
    v_exp_f32 v20, v20
    v_exp_f32 v21, v21
    v_exp_f32 v22, v22
    v_exp_f32 v23, v23
    v_smfmac_f32_32x32x32_bf16 v[60:75], v[144:147], v[12:19], v210
    ds_read_b64_tr_b16 v[80:81], v212 offset:2400
    ds_read_b64_tr_b16 v[82:83], v212 offset:2720
    v_exp_f32 v24, v24
    v_exp_f32 v25, v25
    v_exp_f32 v26, v26
    v_exp_f32 v27, v27
    v_mfma_f32_32x32x16_bf16 v[216:231], v[104:107], v[88:91], 0
    ds_read_b64_tr_b16 v[100:101], v213 offset:640
    ds_read_b64_tr_b16 v[102:103], v213 offset:1440
    v_exp_f32 v28, v28
    v_exp_f32 v29, v29
    v_exp_f32 v30, v30
    v_exp_f32 v31, v31
    v_mfma_f32_32x32x8_bf16 v[216:231], v[132:133], v[94:95], v[216:231]
    v_exp_f32 v32, v32
    v_exp_f32 v33, v33
    v_exp_f32 v34, v34
    v_exp_f32 v35, v35
    v_smfmac_f32_32x32x32_bf16 v[60:75], v[148:151], v[20:27], v210
    ds_write_b128 v211, v[44:47] offset:0
    v_exp_f32 v36, v36
    v_exp_f32 v37, v37
    v_exp_f32 v38, v38
    v_exp_f32 v39, v39
    v_smfmac_f32_32x32x32_bf16 v[60:75], v[152:155], v[28:35], v210
    ds_write_b128 v211, v[48:51] offset:1024
    v_exp_f32 v40, v40
    v_exp_f32 v41, v41
    v_exp_f32 v42, v42
    v_exp_f32 v43, v43
    v_mfma_f32_32x32x16_bf16 v[232:247], v[108:111], v[88:91], 0
    s_setprio 0
    v_exp_f32 v216, v216
    v_exp_f32 v217, v217
    v_exp_f32 v218, v218
    v_exp_f32 v219, v219
    v_mfma_f32_32x32x8_bf16 v[232:247], v[134:135], v[94:95], v[232:247]
    ds_write_b128 v211, v[52:55] offset:2048
    v_exp_f32 v220, v220
    v_exp_f32 v221, v221
    v_exp_f32 v222, v222
    v_exp_f32 v223, v223
    v_smfmac_f32_32x32x32_bf16 v[60:75], v[156:159], v[36:43], v210
    v_exp_f32 v224, v224
    v_exp_f32 v225, v225
    v_exp_f32 v226, v226
    v_exp_f32 v227, v227
    v_smfmac_f32_32x32x32_bf16 v[60:75], v[160:163], v[216:223], v210
    v_exp_f32 v228, v228
    v_exp_f32 v229, v229
    v_exp_f32 v230, v230
    v_exp_f32 v231, v231
    v_mfma_f32_32x32x16_bf16 v[12:27], v[112:115], v[88:91], 0
    v_exp_f32 v232, v232
    v_exp_f32 v233, v233
    v_exp_f32 v234, v234
    v_exp_f32 v235, v235
    v_mfma_f32_32x32x8_bf16 v[12:27], v[136:137], v[94:95], v[12:27]
    v_add_u32 v211, s57, v214
    v_exp_f32 v236, v236
    v_exp_f32 v237, v237
    v_exp_f32 v238, v238
    v_exp_f32 v239, v239
    v_smfmac_f32_32x32x32_bf16 v[60:75], v[164:167], v[224:231], v210
    v_sub_u32 v7, v211, v248
    v_exp_f32 v240, v240
    v_exp_f32 v241, v241
    v_exp_f32 v242, v242
    v_exp_f32 v243, v243
    v_smfmac_f32_32x32x32_bf16 v[60:75], v[168:171], v[232:239], v210
    v_exp_f32 v244, v244
    v_exp_f32 v245, v245
    v_exp_f32 v246, v246
    v_exp_f32 v247, v247
    s_waitcnt lgkmcnt(0)
    s_barrier
    v_mfma_f32_32x32x16_bf16 v[28:43], v[116:119], v[88:91], 0
    s_setprio 3
    v_exp_f32 v12, v12
    v_exp_f32 v13, v13
    v_exp_f32 v14, v14
    v_exp_f32 v15, v15
    v_mfma_f32_32x32x8_bf16 v[28:43], v[138:139], v[94:95], v[28:43]
    ds_read_b128 v[44:47], v211 offset:0
    v_exp_f32 v16, v16
    v_exp_f32 v17, v17
    v_exp_f32 v18, v18
    v_exp_f32 v19, v19
    v_smfmac_f32_32x32x32_bf16 v[60:75], v[172:175], v[240:247], v210
    ds_read_b128 v[48:51], v211 offset:1024
    v_exp_f32 v20, v20
    v_exp_f32 v21, v21
    v_exp_f32 v22, v22
    v_exp_f32 v23, v23
    v_smfmac_f32_32x32x32_bf16 v[60:75], v[176:179], v[12:19], v210
    ds_read_b128 v[52:55], v211 offset:2048
    v_exp_f32 v24, v24
    v_exp_f32 v25, v25
    v_exp_f32 v26, v26
    v_exp_f32 v27, v27
    v_mfma_f32_32x32x16_bf16 v[216:231], v[120:123], v[88:91], 0
    v_exp_f32 v28, v28
    v_exp_f32 v29, v29
    v_exp_f32 v30, v30
    v_exp_f32 v31, v31
    v_mfma_f32_32x32x8_bf16 v[216:231], v[140:141], v[94:95], v[216:231]
    v_exp_f32 v32, v32
    v_exp_f32 v33, v33
    v_exp_f32 v34, v34
    v_exp_f32 v35, v35
    v_smfmac_f32_32x32x32_bf16 v[60:75], v[180:183], v[20:27], v210
    v_exp_f32 v36, v36
    v_exp_f32 v37, v37
    v_exp_f32 v38, v38
    v_exp_f32 v39, v39
    v_smfmac_f32_32x32x32_bf16 v[60:75], v[184:187], v[28:35], v210
    v_exp_f32 v40, v40
    v_exp_f32 v41, v41
    v_exp_f32 v42, v42
    v_exp_f32 v43, v43
    v_mfma_f32_32x32x16_bf16 v[232:247], v[124:127], v[88:91], 0
    s_setprio 2
    v_exp_f32 v216, v216
    v_exp_f32 v217, v217
    v_exp_f32 v218, v218
    v_exp_f32 v219, v219
    v_mfma_f32_32x32x8_bf16 v[232:247], v[142:143], v[94:95], v[232:247]
    v_exp_f32 v220, v220
    v_exp_f32 v221, v221
    v_exp_f32 v222, v222
    v_exp_f32 v223, v223
    v_smfmac_f32_32x32x32_bf16 v[60:75], v[188:191], v[36:43], v210
    v_exp_f32 v224, v224
    v_exp_f32 v225, v225
    v_exp_f32 v226, v226
    v_exp_f32 v227, v227
    v_smfmac_f32_32x32x32_bf16 v[60:75], v[192:195], v[216:223], v210
    v_exp_f32 v228, v228
    v_exp_f32 v229, v229
    v_exp_f32 v230, v230
    v_exp_f32 v231, v231
    v_exp_f32 v232, v232
    v_exp_f32 v233, v233
    v_exp_f32 v234, v234
    v_exp_f32 v235, v235
    v_exp_f32 v236, v236
    v_exp_f32 v237, v237
    v_exp_f32 v238, v238
    v_exp_f32 v239, v239
    v_smfmac_f32_32x32x32_bf16 v[60:75], v[196:199], v[224:231], v210
    v_exp_f32 v240, v240
    v_exp_f32 v241, v241
    v_exp_f32 v242, v242
    v_exp_f32 v243, v243
    v_smfmac_f32_32x32x32_bf16 v[60:75], v[200:203], v[232:239], v210
    v_exp_f32 v244, v244
    v_exp_f32 v245, v245
    v_exp_f32 v246, v246
    v_exp_f32 v247, v247
    s_setprio 0
    s_nop 0
    v_smfmac_f32_32x32x32_bf16 v[60:75], v[204:207], v[240:247], v210
    s_waitcnt lgkmcnt(0)
    s_nop 10
    v_add_f32 v60, v60, v44
    v_add_f32 v61, v61, v45
    v_add_f32 v62, v62, v46
    v_add_f32 v63, v63, v47
    v_add_f32 v64, v64, v48
    v_add_f32 v65, v65, v49
    v_add_f32 v66, v66, v50
    v_add_f32 v67, v67, v51
    v_add_f32 v68, v68, v52
    v_add_f32 v69, v69, v53
    v_add_f32 v70, v70, v54
    v_add_f32 v71, v71, v55
    v_mov_b32 v5, v68
    v_mov_b32 v6, v68
    s_nop 1
    v_permlane32_swap_b32 v6, v5
    v_rcp_f32 v5, v5
    s_nop 0
    v_mul_f32 v60, v60, v5
    v_mul_f32 v61, v61, v5
    v_mul_f32 v62, v62, v5
    v_mul_f32 v63, v63, v5
    v_mul_f32 v64, v64, v5
    v_mul_f32 v65, v65, v5
    v_mul_f32 v66, v66, v5
    v_mul_f32 v67, v67, v5
    v_mul_f32 v68, v68, v5
    v_mul_f32 v69, v69, v5
    v_mul_f32 v70, v70, v5
    v_mul_f32 v71, v71, v5
    v_cvt_pk_bf16_f32 v28, v60, v61
    v_cvt_pk_bf16_f32 v29, v62, v63
    v_cvt_pk_bf16_f32 v30, v64, v65
    v_cvt_pk_bf16_f32 v31, v66, v67
    v_cvt_pk_bf16_f32 v32, v68, v69
    v_cvt_pk_bf16_f32 v33, v70, v71
    buffer_store_dwordx4 v[28:31], v4, s[8:11], s45 offen sc1
    s_mov_b32 exec_hi, 0
    buffer_store_dwordx2 v[32:33], v248, s[8:11], s46 offen sc1
    ds_write_b64 v7, v[32:33] offset:1024
    s_mov_b64 exec, -1
    ds_write_b128 v211, v[28:31]
    s_and_b32 s76, s76, 7
    s_mul_i32 s74, s76, 3200
    v_add_u32 v212, s74, v208
    v_add_u32 v213, s74, v209
    s_add_u32 s76, s76, s80
    ds_read_b64_tr_b16 v[128:129], v212 offset:0
    ds_read_b64_tr_b16 v[130:131], v212 offset:320
    ds_read_b64_tr_b16 v[144:145], v212 offset:800
    ds_read_b64_tr_b16 v[146:147], v212 offset:1120
    ds_read_b64_tr_b16 v[104:105], v212 offset:1600
    ds_read_b64_tr_b16 v[106:107], v212 offset:1920
    ds_read_b64_tr_b16 v[148:149], v212 offset:2400
    ds_read_b64_tr_b16 v[150:151], v212 offset:2720
    ds_read_b64_tr_b16 v[152:153], v213 offset:640
    ds_read_b64_tr_b16 v[154:155], v213 offset:1440
    s_and_b32 s76, s76, 7
    s_mul_i32 s74, s76, 3200
    v_add_u32 v212, s74, v208
    v_add_u32 v213, s74, v209
    s_add_u32 s76, s76, s80
    ds_read_b64_tr_b16 v[108:109], v212 offset:0
    ds_read_b64_tr_b16 v[110:111], v212 offset:320
    ds_read_b64_tr_b16 v[132:133], v212 offset:800
    ds_read_b64_tr_b16 v[134:135], v212 offset:1120
    ds_read_b64_tr_b16 v[156:157], v212 offset:1600
    ds_read_b64_tr_b16 v[158:159], v212 offset:1920
    ds_read_b64_tr_b16 v[160:161], v212 offset:2400
    ds_read_b64_tr_b16 v[162:163], v212 offset:2720
    ds_read_b64_tr_b16 v[112:113], v213 offset:640
    ds_read_b64_tr_b16 v[114:115], v213 offset:1440
    s_waitcnt vmcnt(0) lgkmcnt(15)
    s_barrier
    s_cmp_lg_u32 s68, 7
    s_cbranch_scc1 L_t_nf
    s_lshl_b32 s74, s84, 7
    s_add_u32 s74, s74, 0xd14000
    v_mov_b32 v7, s71
    v_lshlrev_b32 v8, 2, v1
    s_mov_b32 exec_hi, 0
    buffer_store_dword v7, v8, s[8:11], s74 offen sc1
    s_mov_b64 exec, -1
L_t_nf:
    s_and_b32 s76, s76, 7
    s_mul_i32 s74, s76, 3200
    v_add_u32 v212, s74, v208
    v_add_u32 v213, s74, v209
    s_add_u32 s76, s76, s80
    ds_read_b64_tr_b16 v[164:165], v212 offset:0
    ds_read_b64_tr_b16 v[166:167], v212 offset:320
    ds_read_b64_tr_b16 v[168:169], v212 offset:800
    ds_read_b64_tr_b16 v[170:171], v212 offset:1120
    ds_read_b64_tr_b16 v[116:117], v212 offset:1600
    ds_read_b64_tr_b16 v[118:119], v212 offset:1920
    ds_read_b64_tr_b16 v[136:137], v212 offset:2400
    ds_read_b64_tr_b16 v[138:139], v212 offset:2720
    ds_read_b64_tr_b16 v[172:173], v213 offset:640
    ds_read_b64_tr_b16 v[174:175], v213 offset:1440
    s_cmp_ge_u32 s85, 2
    s_cbranch_scc1 L_t_small_a
    s_and_b32 s76, s76, 7
    s_mul_i32 s74, s76, 3200
    v_add_u32 v212, s74, v208
    v_add_u32 v213, s74, v209
    s_add_u32 s76, s76, s80
    ds_read_b64_tr_b16 v[176:177], v212 offset:0
    ds_read_b64_tr_b16 v[178:179], v212 offset:320
    ds_read_b64_tr_b16 v[120:121], v212 offset:800
    ds_read_b64_tr_b16 v[122:123], v212 offset:1120
    ds_read_b64_tr_b16 v[180:181], v212 offset:1600
    ds_read_b64_tr_b16 v[182:183], v212 offset:1920
    ds_read_b64_tr_b16 v[184:185], v212 offset:2400
    ds_read_b64_tr_b16 v[186:187], v212 offset:2720
    ds_read_b64_tr_b16 v[124:125], v213 offset:640
    ds_read_b64_tr_b16 v[126:127], v213 offset:1440
    s_and_b32 s76, s76, 7
    s_mul_i32 s74, s76, 3200
    v_add_u32 v212, s74, v208
    v_add_u32 v213, s74, v209
    s_add_u32 s76, s76, s80
    ds_read_b64_tr_b16 v[140:141], v212 offset:0
    ds_read_b64_tr_b16 v[142:143], v212 offset:320
    ds_read_b64_tr_b16 v[188:189], v212 offset:800
    ds_read_b64_tr_b16 v[190:191], v212 offset:1120
    ds_read_b64_tr_b16 v[192:193], v212 offset:1600
    ds_read_b64_tr_b16 v[194:195], v212 offset:1920
    ds_read_b64_tr_b16 v[196:197], v212 offset:2400
    ds_read_b64_tr_b16 v[198:199], v212 offset:2720
    ds_read_b64_tr_b16 v[200:201], v213 offset:640
    ds_read_b64_tr_b16 v[202:203], v213 offset:1440
    s_and_b32 s76, s76, 7
    s_mul_i32 s74, s76, 3200
    v_add_u32 v212, s74, v208
    v_add_u32 v213, s74, v209
    s_add_u32 s76, s76, s80
    ds_read_b64_tr_b16 v[44:45], v212 offset:0
    ds_read_b64_tr_b16 v[46:47], v212 offset:320
    ds_read_b64_tr_b16 v[48:49], v212 offset:800
    ds_read_b64_tr_b16 v[50:51], v212 offset:1120
    ds_read_b64_tr_b16 v[52:53], v212 offset:1600
    ds_read_b64_tr_b16 v[54:55], v212 offset:1920
    ds_read_b64_tr_b16 v[56:57], v212 offset:2400
    ds_read_b64_tr_b16 v[58:59], v212 offset:2720
    ds_read_b64_tr_b16 v[60:61], v213 offset:640
    ds_read_b64_tr_b16 v[62:63], v213 offset:1440
    s_and_b32 s76, s76, 7
    s_mul_i32 s74, s76, 3200
    v_add_u32 v212, s74, v208
    v_add_u32 v213, s74, v209
    s_add_u32 s76, s76, s80
    ds_read_b64_tr_b16 v[64:65], v212 offset:0
    ds_read_b64_tr_b16 v[66:67], v212 offset:320
    ds_read_b64_tr_b16 v[68:69], v212 offset:800
    ds_read_b64_tr_b16 v[70:71], v212 offset:1120
    ds_read_b64_tr_b16 v[72:73], v212 offset:1600
    ds_read_b64_tr_b16 v[74:75], v212 offset:1920
    ds_read_b64_tr_b16 v[88:89], v212 offset:2400
    ds_read_b64_tr_b16 v[90:91], v212 offset:2720
    ds_read_b64_tr_b16 v[92:93], v213 offset:640
    ds_read_b64_tr_b16 v[94:95], v213 offset:1440
    s_branch L_t_frag_done
L_t_small_a:
    s_and_b32 s72, s68, 1
    s_mul_i32 s73, s72, 5120
    v_add_u32 v212, s73, v4
    s_lshl_b32 s75, s7, 6
    s_add_u32 s73, s73, s75
    s_add_u32 s75, s75, 162304
    v_lshl_add_u32 v7, v3, 3, s75
    v_mul_u32_u24 v5, 160, v2
    v_lshl_add_u32 v5, v3, 3, v5
    v_add_u32 v5, s73, v5
    v_bfe_u32 v6, v1, 2, 2
    v_lshl_add_u32 v6, v3, 2, v6
    v_lshlrev_b32 v6, 7, v6
    v_and_b32 v214, 3, v1
    v_lshl_add_u32 v6, v214, 3, v6
    v_bfe_u32 v214, v1, 4, 1
    v_lshl_add_u32 v6, v214, 5, v6
    s_lshl_b32 s73, s72, 6
    s_lshl_b32 s75, s7, 12
    s_add_u32 s73, s73, s75
    v_add_u32 v6, s73, v6
    v_mul_u32_u24 v214, 1280, v2
    v_lshl_add_u32 v214, v3, 4, v214
    s_mul_i32 s73, s3, 10240
    s_add_u32 s73, s73, 22528
    v_add_u32 v212, s73, v212
    v_lshlrev_b32 v215, 3, v2
    v_sub_u32 v215, v212, v215
    s_mul_i32 s72, s72, 3072
    s_add_u32 s72, s72, 137472
    v_add_u32 v211, s72, v4
    v_mul_u32_u24 v213, 12288, v3
    v_lshl_add_u32 v213, v2, 3, v213
    v_add_u32 v213, s72, v213
    s_lshl_b32 s72, s3, 2
    s_add_u32 s72, s72, 162048
    v_mov_b32 v249, s72
    ds_read_b64 v[232:233], v5 offset:0
    ds_read_b64 v[240:241], v7 offset:0
    ds_read_b64_tr_b16 v[224:225], v6 offset:10240
    ds_read_b64 v[234:235], v5 offset:16
    ds_read_b64 v[242:243], v7 offset:16
    ds_read_b64_tr_b16 v[226:227], v6 offset:11264
    ds_read_b64 v[236:237], v5 offset:32
    ds_read_b64 v[244:245], v7 offset:32
    ds_read_b64_tr_b16 v[228:229], v6 offset:12288
    ds_read_b64 v[238:239], v5 offset:48
    ds_read_b64 v[246:247], v7 offset:48
    ds_read_b64_tr_b16 v[230:231], v6 offset:13312
    s_lshl_b32 s72, s68, 2
    s_add_u32 s72, s72, 162048
    v_mov_b32 v204, s72
    v_mov_b32 v205, 1
    v_mov_b32 v12, 0
    v_mov_b32 v13, 0
    v_mov_b32 v14, 0
    v_mov_b32 v15, 0
    v_mov_b32 v16, 0
    v_mov_b32 v17, 0
    v_mov_b32 v18, 0
    v_mov_b32 v19, 0
    v_mov_b32 v20, 0
    v_mov_b32 v21, 0
    v_mov_b32 v22, 0
    v_mov_b32 v23, 0
    v_mov_b32 v24, 0
    v_mov_b32 v25, 0
    v_mov_b32 v26, 0
    v_mov_b32 v27, 0
L_t_frag_done:
    s_add_u32 s72, s68, s70
    s_and_b32 s72, s72, 7
    s_lshl_b32 s73, s69, 3
    s_add_u32 s84, s72, s73
    s_lshl_b32 s82, s84, 7
    s_add_u32 s82, s82, 0xd14000
    v_mov_b32 v8, 0
    s_mov_b64 exec, 1
    buffer_load_dword v210, v8, s[8:11], s82 offen sc1
    s_mov_b64 exec, -1
    s_mul_i32 s81, s84, 10240
    s_mul_i32 s83, s68, 10240
    s_add_u32 s83, s83, 22528
    s_cmp_eq_u32 s68, 0
    s_cselect_b32 s87, 1, 0
    s_waitcnt lgkmcnt(0)
    s_barrier
    s_waitcnt vmcnt(0)
    s_cmp_lg_u32 s87, 0
    s_cbranch_scc1 L_t_f2
    s_mov_b64 exec, 1
    s_mov_b32 s75, 100000
    s_branch L_po_chk
L_po_retry:
    buffer_load_dword v210, v8, s[8:11], s82 offen sc1
    s_waitcnt vmcnt(0)
L_po_chk:
    v_cmp_ne_u32 vcc, s71, v210
    s_nop 4
    s_cbranch_vccz L_po_ok
    s_mov_b64 exec, vcc
    s_sleep 1
    s_sub_u32 s75, s75, 1
    s_cmp_lg_u32 s75, 0
    s_cbranch_scc1 L_po_retry
    s_endpgm
L_po_ok:
    s_mov_b64 exec, -1
    s_add_u32 m0, s83, 0
    s_add_u32 s73, s81, 0
    buffer_load_dwordx4 v4, s[8:11], s73 offen offset:0 sc1 lds
    buffer_load_dwordx4 v4, s[8:11], s73 offen offset:1024 sc1 lds
    buffer_load_dwordx4 v4, s[8:11], s73 offen offset:2048 sc1 lds
    buffer_load_dwordx4 v4, s[8:11], s73 offen offset:3072 sc1 lds
    s_add_u32 m0, s83, 4096
    s_add_u32 s73, s81, 4096
    buffer_load_dwordx4 v4, s[8:11], s73 offen offset:0 sc1 lds
    buffer_load_dwordx4 v4, s[8:11], s73 offen offset:1024 sc1 lds
    buffer_load_dwordx4 v4, s[8:11], s73 offen offset:2048 sc1 lds
    buffer_load_dwordx4 v4, s[8:11], s73 offen offset:3072 sc1 lds
    s_add_u32 m0, s83, 8192
    s_add_u32 s73, s81, 8192
    buffer_load_dwordx4 v4, s[8:11], s73 offen offset:0 sc1 lds
    buffer_load_dwordx4 v4, s[8:11], s73 offen offset:1024 sc1 lds
    s_mov_b32 s87, 1
L_t_f2:
    s_cmp_ge_u32 s85, 2
    s_cbranch_scc1 L_t_a2
    s_and_b32 s72, s68, 1
    s_mul_i32 s73, s72, 5120
    v_add_u32 v212, s73, v4
    s_lshl_b32 s75, s7, 6
    s_add_u32 s73, s73, s75
    s_add_u32 s75, s75, 162304
    v_lshl_add_u32 v7, v3, 3, s75
    v_mul_u32_u24 v5, 160, v2
    v_lshl_add_u32 v5, v3, 3, v5
    v_add_u32 v5, s73, v5
    v_bfe_u32 v6, v1, 2, 2
    v_lshl_add_u32 v6, v3, 2, v6
    v_lshlrev_b32 v6, 7, v6
    v_and_b32 v214, 3, v1
    v_lshl_add_u32 v6, v214, 3, v6
    v_bfe_u32 v214, v1, 4, 1
    v_lshl_add_u32 v6, v214, 5, v6
    s_lshl_b32 s73, s72, 6
    s_lshl_b32 s75, s7, 12
    s_add_u32 s73, s73, s75
    v_add_u32 v6, s73, v6
    v_mul_u32_u24 v214, 1280, v2
    v_lshl_add_u32 v214, v3, 4, v214
    s_mul_i32 s73, s3, 10240
    s_add_u32 s73, s73, 22528
    v_add_u32 v212, s73, v212
    v_lshlrev_b32 v215, 3, v2
    v_sub_u32 v215, v212, v215
    s_mul_i32 s72, s72, 3072
    s_add_u32 s72, s72, 137472
    v_add_u32 v211, s72, v4
    v_mul_u32_u24 v213, 12288, v3
    v_lshl_add_u32 v213, v2, 3, v213
    v_add_u32 v213, s72, v213
    s_lshl_b32 s72, s3, 2
    s_add_u32 s72, s72, 162048
    v_mov_b32 v249, s72
    ds_read_b64 v[232:233], v5 offset:0
    ds_read_b64 v[240:241], v7 offset:0
    ds_read_b64_tr_b16 v[224:225], v6 offset:10240
    ds_read_b64 v[234:235], v5 offset:16
    ds_read_b64 v[242:243], v7 offset:16
    ds_read_b64_tr_b16 v[226:227], v6 offset:11264
    ds_read_b64 v[236:237], v5 offset:32
    ds_read_b64 v[244:245], v7 offset:32
    ds_read_b64_tr_b16 v[228:229], v6 offset:12288
    ds_read_b64 v[238:239], v5 offset:48
    ds_read_b64 v[246:247], v7 offset:48
    ds_read_b64_tr_b16 v[230:231], v6 offset:13312
    s_lshl_b32 s72, s68, 2
    s_add_u32 s72, s72, 162048
    v_mov_b32 v204, s72
    v_mov_b32 v205, 1
    v_mov_b32 v12, 0
    v_mov_b32 v13, 0
    v_mov_b32 v14, 0
    v_mov_b32 v15, 0
    v_mov_b32 v16, 0
    v_mov_b32 v17, 0
    v_mov_b32 v18, 0
    v_mov_b32 v19, 0
    v_mov_b32 v20, 0
    v_mov_b32 v21, 0
    v_mov_b32 v22, 0
    v_mov_b32 v23, 0
    v_mov_b32 v24, 0
    v_mov_b32 v25, 0
    v_mov_b32 v26, 0
    v_mov_b32 v27, 0
L_t_a2:
    s_cmp_eq_u32 s85, 3
    s_cbranch_scc1 L_t_noown
    ds_read_b128 v[28:31], v211 offset:0
    ds_read_b128 v[32:35], v211 offset:6144
    ds_read_b128 v[36:39], v211 offset:12288
    ds_read_b128 v[40:43], v211 offset:18432
    s_waitcnt lgkmcnt(3)
    v_mfma_f32_32x32x16_bf16 v[12:27], v[96:99], v[28:31], v[12:27]
    ds_read_b64 v[28:29], v213 offset:1024
    ds_read_b64 v[30:31], v213 offset:7168
    s_waitcnt lgkmcnt(4)
    v_mfma_f32_32x32x16_bf16 v[12:27], v[84:87], v[32:35], v[12:27]
    s_waitcnt lgkmcnt(3)
    v_mfma_f32_32x32x16_bf16 v[12:27], v[76:79], v[36:39], v[12:27]
    s_waitcnt lgkmcnt(2)
    v_mfma_f32_32x32x16_bf16 v[12:27], v[80:83], v[40:43], v[12:27]
    s_waitcnt lgkmcnt(0)
    v_mfma_f32_32x32x16_bf16 v[12:27], v[100:103], v[28:31], v[12:27]
L_t_noown:
    v_add_u32 v211, 61440, v212
    v_add_u32 v213, 61440, v215
    v_mov_b32 v206, 0
    v_mov_b32 v207, 0
    s_waitcnt lgkmcnt(0)
    s_waitcnt vmcnt(0)
    ds_write_b32 v204, v205
    s_mov_b32 s75, 3000000
    s_cmp_ge_u32 s85, 2
    s_cbranch_scc1 L_t_sm0
L_gb1:
    v_readfirstlane_b32 s72, v207
    s_nop 0
    s_cmp_eq_u32 s72, 0
    s_cbranch_scc1 L_gsb1
    ds_read_b128 v[28:31], v212 offset:10240
    ds_read_b128 v[32:35], v212 offset:11264
    ds_read_b32 v206, v249 offset:8
    ds_read_b128 v[36:39], v212 offset:12288
    ds_read_b128 v[40:43], v212 offset:13312
    s_waitcnt lgkmcnt(4)
    v_mfma_f32_32x32x16_bf16 v[12:27], v[128:131], v[28:31], v[12:27]
    v_lshlrev_b32 v5, 16, v232
    v_lshlrev_b32 v6, 16, v240
    v_lshlrev_b32 v7, 16, v224
    ds_read_b64 v[28:29], v215 offset:14336
    ds_read_b64 v[30:31], v215 offset:14592
    s_waitcnt lgkmcnt(5)
    v_mfma_f32_32x32x16_bf16 v[12:27], v[144:147], v[32:35], v[12:27]
    v_fmac_f32 v7, v5, v6
    v_mul_f32 v216, v7, v10
    v_and_b32 v5, s92, v232
    s_waitcnt lgkmcnt(4)
L_gb2:
    v_readfirstlane_b32 s72, v206
    s_nop 0
    s_cmp_eq_u32 s72, 0
    s_cbranch_scc1 L_gsb2
    ds_read_b128 v[32:35], v212 offset:20480
    s_waitcnt lgkmcnt(4)
    v_mfma_f32_32x32x16_bf16 v[12:27], v[104:107], v[36:39], v[12:27]
    v_and_b32 v6, s92, v240
    v_and_b32 v7, s92, v224
    v_fmac_f32 v7, v5, v6
    ds_read_b128 v[36:39], v212 offset:21504
    ds_read_b32 v207, v249 offset:12
    s_waitcnt lgkmcnt(5)
    v_mfma_f32_32x32x16_bf16 v[12:27], v[148:151], v[40:43], v[12:27]
    v_mul_f32 v217, v7, v10
    v_lshlrev_b32 v5, 16, v233
    v_lshlrev_b32 v6, 16, v241
    ds_read_b128 v[40:43], v212 offset:22528
    s_waitcnt lgkmcnt(4)
    v_mfma_f32_32x32x16_bf16 v[12:27], v[152:155], v[28:31], v[12:27]
    v_lshlrev_b32 v7, 16, v225
    v_fmac_f32 v7, v5, v6
    v_mul_f32 v218, v7, v10
    ds_read_b128 v[28:31], v212 offset:23552
    s_waitcnt lgkmcnt(4)
    v_mfma_f32_32x32x16_bf16 v[12:27], v[108:111], v[32:35], v[12:27]
    v_and_b32 v5, s92, v233
    v_and_b32 v6, s92, v241
    v_and_b32 v7, s92, v225
    ds_read_b64 v[32:33], v215 offset:24576
    ds_read_b64 v[34:35], v215 offset:24832
    s_waitcnt lgkmcnt(5)
    v_mfma_f32_32x32x16_bf16 v[12:27], v[132:135], v[36:39], v[12:27]
    v_fmac_f32 v7, v5, v6
    v_mul_f32 v219, v7, v10
    v_lshlrev_b32 v5, 16, v234
    s_waitcnt lgkmcnt(4)
L_gb3:
    v_readfirstlane_b32 s72, v207
    s_nop 0
    s_cmp_eq_u32 s72, 0
    s_cbranch_scc1 L_gsb3
    ds_read_b128 v[36:39], v212 offset:30720
    s_waitcnt lgkmcnt(4)
    v_mfma_f32_32x32x16_bf16 v[12:27], v[156:159], v[40:43], v[12:27]
    v_lshlrev_b32 v6, 16, v242
    v_lshlrev_b32 v7, 16, v226
    v_fmac_f32 v7, v5, v6
    ds_read_b128 v[40:43], v212 offset:31744
    ds_read_b32 v206, v249 offset:16
    s_waitcnt lgkmcnt(5)
    v_mfma_f32_32x32x16_bf16 v[12:27], v[160:163], v[28:31], v[12:27]
    v_mul_f32 v220, v7, v10
    v_and_b32 v5, s92, v234
    v_and_b32 v6, s92, v242
    ds_read_b128 v[28:31], v212 offset:32768
    s_waitcnt lgkmcnt(4)
    v_mfma_f32_32x32x16_bf16 v[12:27], v[112:115], v[32:35], v[12:27]
    v_and_b32 v7, s92, v226
    v_fmac_f32 v7, v5, v6
    v_mul_f32 v221, v7, v10
    ds_read_b128 v[32:35], v212 offset:33792
    s_waitcnt lgkmcnt(4)
    v_mfma_f32_32x32x16_bf16 v[12:27], v[164:167], v[36:39], v[12:27]
    v_lshlrev_b32 v5, 16, v235
    v_lshlrev_b32 v6, 16, v243
    v_lshlrev_b32 v7, 16, v227
    ds_read_b64 v[36:37], v215 offset:34816
    ds_read_b64 v[38:39], v215 offset:35072
    s_waitcnt lgkmcnt(5)
    v_mfma_f32_32x32x16_bf16 v[12:27], v[168:171], v[40:43], v[12:27]
    v_fmac_f32 v7, v5, v6
    v_mul_f32 v222, v7, v10
    v_and_b32 v5, s92, v235
    s_waitcnt lgkmcnt(4)
L_gb4:
    v_readfirstlane_b32 s72, v206
    s_nop 0
    s_cmp_eq_u32 s72, 0
    s_cbranch_scc1 L_gsb4
    ds_read_b128 v[40:43], v212 offset:40960
    s_waitcnt lgkmcnt(4)
    v_mfma_f32_32x32x16_bf16 v[12:27], v[116:119], v[28:31], v[12:27]
    v_and_b32 v6, s92, v243
    v_and_b32 v7, s92, v227
    v_fmac_f32 v7, v5, v6
    ds_read_b128 v[28:31], v212 offset:41984
    ds_read_b32 v207, v249 offset:20
    s_waitcnt lgkmcnt(5)
    v_mfma_f32_32x32x16_bf16 v[12:27], v[136:139], v[32:35], v[12:27]
    v_mul_f32 v223, v7, v10
    v_lshlrev_b32 v5, 16, v236
    v_lshlrev_b32 v6, 16, v244
    ds_read_b128 v[32:35], v212 offset:43008
    s_waitcnt lgkmcnt(4)
    v_mfma_f32_32x32x16_bf16 v[12:27], v[172:175], v[36:39], v[12:27]
    v_lshlrev_b32 v7, 16, v228
    v_fmac_f32 v7, v5, v6
    v_mul_f32 v224, v7, v10
    ds_read_b128 v[36:39], v212 offset:44032
    s_waitcnt lgkmcnt(4)
    v_mfma_f32_32x32x16_bf16 v[12:27], v[176:179], v[40:43], v[12:27]
    v_and_b32 v5, s92, v236
    v_and_b32 v6, s92, v244
    v_and_b32 v7, s92, v228
    ds_read_b64 v[40:41], v215 offset:45056
    ds_read_b64 v[42:43], v215 offset:45312
    s_waitcnt lgkmcnt(5)
    v_mfma_f32_32x32x16_bf16 v[12:27], v[120:123], v[28:31], v[12:27]
    v_fmac_f32 v7, v5, v6
    v_mul_f32 v225, v7, v10
    v_lshlrev_b32 v5, 16, v237
    s_waitcnt lgkmcnt(4)
L_gb5:
    v_readfirstlane_b32 s72, v207
    s_nop 0
    s_cmp_eq_u32 s72, 0
    s_cbranch_scc1 L_gsb5
    ds_read_b128 v[28:31], v212 offset:51200
    s_waitcnt lgkmcnt(4)
    v_mfma_f32_32x32x16_bf16 v[12:27], v[180:183], v[32:35], v[12:27]
    v_lshlrev_b32 v6, 16, v245
    v_lshlrev_b32 v7, 16, v229
    v_fmac_f32 v7, v5, v6
    ds_read_b128 v[32:35], v212 offset:52224
    ds_read_b32 v206, v249 offset:24
    s_waitcnt lgkmcnt(5)
    v_mfma_f32_32x32x16_bf16 v[12:27], v[184:187], v[36:39], v[12:27]
    v_mul_f32 v226, v7, v10
    v_and_b32 v5, s92, v237
    v_and_b32 v6, s92, v245
    ds_read_b128 v[36:39], v212 offset:53248
    s_waitcnt lgkmcnt(4)
    v_mfma_f32_32x32x16_bf16 v[12:27], v[124:127], v[40:43], v[12:27]
    v_and_b32 v7, s92, v229
    v_fmac_f32 v7, v5, v6
    v_mul_f32 v227, v7, v10
    ds_read_b128 v[40:43], v212 offset:54272
    s_waitcnt lgkmcnt(4)
    v_mfma_f32_32x32x16_bf16 v[12:27], v[140:143], v[28:31], v[12:27]
    v_lshlrev_b32 v5, 16, v238
    v_lshlrev_b32 v6, 16, v246
    v_lshlrev_b32 v7, 16, v230
    ds_read_b64 v[28:29], v215 offset:55296
    ds_read_b64 v[30:31], v215 offset:55552
    s_waitcnt lgkmcnt(5)
    v_mfma_f32_32x32x16_bf16 v[12:27], v[188:191], v[32:35], v[12:27]
    v_fmac_f32 v7, v5, v6
    v_mul_f32 v228, v7, v10
    v_and_b32 v5, s92, v238
    s_waitcnt lgkmcnt(4)
L_gb6:
    v_readfirstlane_b32 s72, v206
    s_nop 0
    s_cmp_eq_u32 s72, 0
    s_cbranch_scc1 L_gsb6
    ds_read_b128 v[32:35], v211 offset:0
    s_waitcnt lgkmcnt(4)
    v_mfma_f32_32x32x16_bf16 v[12:27], v[192:195], v[36:39], v[12:27]
    v_and_b32 v6, s92, v246
    v_and_b32 v7, s92, v230
    v_fmac_f32 v7, v5, v6
    ds_read_b128 v[36:39], v211 offset:1024
    ds_read_b32 v207, v249 offset:28
    s_waitcnt lgkmcnt(5)
    v_mfma_f32_32x32x16_bf16 v[12:27], v[196:199], v[40:43], v[12:27]
    v_mul_f32 v229, v7, v10
    v_lshlrev_b32 v5, 16, v239
    v_lshlrev_b32 v6, 16, v247
    ds_read_b128 v[40:43], v211 offset:2048
    s_waitcnt lgkmcnt(4)
    v_mfma_f32_32x32x16_bf16 v[12:27], v[200:203], v[28:31], v[12:27]
    v_lshlrev_b32 v7, 16, v231
    v_fmac_f32 v7, v5, v6
    v_mul_f32 v230, v7, v10
    ds_read_b128 v[28:31], v211 offset:3072
    s_waitcnt lgkmcnt(4)
    v_mfma_f32_32x32x16_bf16 v[12:27], v[44:47], v[32:35], v[12:27]
    v_and_b32 v5, s92, v239
    v_and_b32 v6, s92, v247
    v_and_b32 v7, s92, v231
    ds_read_b64 v[32:33], v213 offset:4096
    ds_read_b64 v[34:35], v213 offset:4352
    s_waitcnt lgkmcnt(5)
    v_mfma_f32_32x32x16_bf16 v[12:27], v[48:51], v[36:39], v[12:27]
    v_fmac_f32 v7, v5, v6
    v_mul_f32 v231, v7, v10
    s_waitcnt lgkmcnt(4)
L_gb7:
    v_readfirstlane_b32 s72, v207
    s_nop 0
    s_cmp_eq_u32 s72, 0
    s_cbranch_scc1 L_gsb7
    ds_read_b128 v[36:39], v211 offset:10240
    s_waitcnt lgkmcnt(4)
    v_mfma_f32_32x32x16_bf16 v[12:27], v[52:55], v[40:43], v[12:27]
    ds_read_b128 v[40:43], v211 offset:11264
    s_waitcnt lgkmcnt(4)
    v_mfma_f32_32x32x16_bf16 v[12:27], v[56:59], v[28:31], v[12:27]
    ds_read_b128 v[28:31], v211 offset:12288
    s_waitcnt lgkmcnt(3)
    v_mfma_f32_32x32x16_bf16 v[12:27], v[60:63], v[32:35], v[12:27]
    ds_read_b128 v[32:35], v211 offset:13312
    s_waitcnt lgkmcnt(3)
    v_mfma_f32_32x32x16_bf16 v[12:27], v[64:67], v[36:39], v[12:27]
    ds_read_b64 v[36:37], v213 offset:14336
    ds_read_b64 v[38:39], v213 offset:14592
    s_waitcnt lgkmcnt(4)
    v_mfma_f32_32x32x16_bf16 v[12:27], v[68:71], v[40:43], v[12:27]
    s_waitcnt lgkmcnt(3)
    v_mfma_f32_32x32x16_bf16 v[12:27], v[72:75], v[28:31], v[12:27]
    s_waitcnt lgkmcnt(2)
    v_mfma_f32_32x32x16_bf16 v[12:27], v[88:91], v[32:35], v[12:27]
    s_waitcnt lgkmcnt(0)
    v_mfma_f32_32x32x16_bf16 v[12:27], v[92:95], v[36:39], v[12:27]
    s_branch L_t_out
L_t_sm0:
    s_cmp_lg_u32 s85, 3
    s_cbranch_scc1 L_t_s1
L_gz0:
    v_readfirstlane_b32 s72, v206
    s_nop 0
    s_cmp_eq_u32 s72, 0
    s_cbranch_scc1 L_gsz0
    ds_read_b128 v[28:31], v212 offset:0
    ds_read_b128 v[32:35], v212 offset:1024
    ds_read_b128 v[36:39], v212 offset:2048
    ds_read_b128 v[40:43], v212 offset:3072
    s_waitcnt lgkmcnt(3)
    v_mfma_f32_32x32x16_bf16 v[12:27], v[96:99], v[28:31], v[12:27]
    ds_read_b64 v[28:29], v215 offset:4096
    ds_read_b64 v[30:31], v215 offset:4352
    s_waitcnt lgkmcnt(4)
    v_mfma_f32_32x32x16_bf16 v[12:27], v[84:87], v[32:35], v[12:27]
    s_waitcnt lgkmcnt(3)
    v_mfma_f32_32x32x16_bf16 v[12:27], v[76:79], v[36:39], v[12:27]
    s_waitcnt lgkmcnt(2)
    v_mfma_f32_32x32x16_bf16 v[12:27], v[80:83], v[40:43], v[12:27]
    s_waitcnt lgkmcnt(0)
    v_mfma_f32_32x32x16_bf16 v[12:27], v[100:103], v[28:31], v[12:27]
L_t_s1:
L_gs1:
    v_readfirstlane_b32 s72, v207
    s_nop 0
    s_cmp_eq_u32 s72, 0
    s_cbranch_scc1 L_gss1
    ds_read_b128 v[28:31], v212 offset:20480
    ds_read_b128 v[32:35], v212 offset:21504
    ds_read_b32 v206, v249 offset:16
    ds_read_b128 v[36:39], v212 offset:22528
    ds_read_b128 v[40:43], v212 offset:23552
    s_waitcnt lgkmcnt(4)
    v_mfma_f32_32x32x16_bf16 v[12:27], v[128:131], v[28:31], v[12:27]
    v_lshlrev_b32 v5, 16, v232
    v_lshlrev_b32 v6, 16, v240
    v_lshlrev_b32 v7, 16, v224
    v_fmac_f32 v7, v5, v6
    ds_read_b64 v[28:29], v215 offset:24576
    ds_read_b64 v[30:31], v215 offset:24832
    s_waitcnt lgkmcnt(5)
    v_mfma_f32_32x32x16_bf16 v[12:27], v[144:147], v[32:35], v[12:27]
    v_mul_f32 v216, v7, v10
    v_and_b32 v5, s92, v232
    v_and_b32 v6, s92, v240
    v_and_b32 v7, s92, v224
    s_waitcnt lgkmcnt(4)
L_gs2:
    v_readfirstlane_b32 s72, v206
    s_nop 0
    s_cmp_eq_u32 s72, 0
    s_cbranch_scc1 L_gss2
    ds_read_b128 v[32:35], v212 offset:40960
    s_waitcnt lgkmcnt(4)
    v_mfma_f32_32x32x16_bf16 v[12:27], v[104:107], v[36:39], v[12:27]
    v_fmac_f32 v7, v5, v6
    v_mul_f32 v217, v7, v10
    v_lshlrev_b32 v5, 16, v233
    v_lshlrev_b32 v6, 16, v241
    ds_read_b128 v[36:39], v212 offset:41984
    ds_read_b32 v207, v249 offset:24
    s_waitcnt lgkmcnt(5)
    v_mfma_f32_32x32x16_bf16 v[12:27], v[148:151], v[40:43], v[12:27]
    v_lshlrev_b32 v7, 16, v225
    v_fmac_f32 v7, v5, v6
    v_mul_f32 v218, v7, v10
    v_and_b32 v5, s92, v233
    ds_read_b128 v[40:43], v212 offset:43008
    s_waitcnt lgkmcnt(4)
    v_mfma_f32_32x32x16_bf16 v[12:27], v[152:155], v[28:31], v[12:27]
    v_and_b32 v6, s92, v241
    v_and_b32 v7, s92, v225
    v_fmac_f32 v7, v5, v6
    v_mul_f32 v219, v7, v10
    ds_read_b128 v[28:31], v212 offset:44032
    s_waitcnt lgkmcnt(4)
    v_mfma_f32_32x32x16_bf16 v[12:27], v[108:111], v[32:35], v[12:27]
    v_lshlrev_b32 v5, 16, v234
    v_lshlrev_b32 v6, 16, v242
    v_lshlrev_b32 v7, 16, v226
    v_fmac_f32 v7, v5, v6
    ds_read_b64 v[32:33], v215 offset:45056
    ds_read_b64 v[34:35], v215 offset:45312
    s_waitcnt lgkmcnt(5)
    v_mfma_f32_32x32x16_bf16 v[12:27], v[132:135], v[36:39], v[12:27]
    v_mul_f32 v220, v7, v10
    v_and_b32 v5, s92, v234
    v_and_b32 v6, s92, v242
    v_and_b32 v7, s92, v226
    s_waitcnt lgkmcnt(4)
L_gs3:
    v_readfirstlane_b32 s72, v207
    s_nop 0
    s_cmp_eq_u32 s72, 0
    s_cbranch_scc1 L_gss3
    ds_read_b128 v[36:39], v211 offset:0
    s_waitcnt lgkmcnt(4)
    v_mfma_f32_32x32x16_bf16 v[12:27], v[156:159], v[40:43], v[12:27]
    v_fmac_f32 v7, v5, v6
    v_mul_f32 v221, v7, v10
    v_lshlrev_b32 v5, 16, v235
    v_lshlrev_b32 v6, 16, v243
    ds_read_b128 v[40:43], v211 offset:1024
    s_waitcnt lgkmcnt(4)
    v_mfma_f32_32x32x16_bf16 v[12:27], v[160:163], v[28:31], v[12:27]
    v_lshlrev_b32 v7, 16, v227
    v_fmac_f32 v7, v5, v6
    v_mul_f32 v222, v7, v10
    v_and_b32 v5, s92, v235
    ds_read_b128 v[28:31], v211 offset:2048
    s_waitcnt lgkmcnt(3)
    v_mfma_f32_32x32x16_bf16 v[12:27], v[112:115], v[32:35], v[12:27]
    v_and_b32 v6, s92, v243
    v_and_b32 v7, s92, v227
    v_fmac_f32 v7, v5, v6
    v_mul_f32 v223, v7, v10
    ds_read_b128 v[32:35], v211 offset:3072
    s_waitcnt lgkmcnt(3)
    v_mfma_f32_32x32x16_bf16 v[12:27], v[164:167], v[36:39], v[12:27]
    ds_read_b64 v[36:37], v213 offset:4096
    ds_read_b64 v[38:39], v213 offset:4352
    s_waitcnt lgkmcnt(4)
    v_mfma_f32_32x32x16_bf16 v[12:27], v[168:171], v[40:43], v[12:27]
    s_waitcnt lgkmcnt(3)
    v_mfma_f32_32x32x16_bf16 v[12:27], v[116:119], v[28:31], v[12:27]
    s_waitcnt lgkmcnt(2)
    v_mfma_f32_32x32x16_bf16 v[12:27], v[136:139], v[32:35], v[12:27]
    s_waitcnt lgkmcnt(0)
    v_mfma_f32_32x32x16_bf16 v[12:27], v[172:175], v[36:39], v[12:27]
L_t_small:
    s_and_b32 s72, s68, 1
    s_lshl_b32 s73, s72, 11
    v_add_u32 v5, s73, v4
    s_lshl_b32 s72, s72, 2
    s_add_u32 s72, s72, 162080
    v_mov_b32 v249, s72
    s_cmp_eq_u32 s85, 2
    s_cbranch_scc1 L_t_recv
    s_nop 3
    ds_write_b128 v5, v[12:15] offset:20480
    ds_write_b128 v5, v[16:19] offset:21504
    ds_write_b32 v249, v205
    s_lshl_b32 s72, s2, 3
    s_add_u32 s72, s72, s68
    s_cmp_lg_u32 s72, 7
    s_cbranch_scc1 L_fin
    v_lshlrev_b32 v5, 7, v1
    s_mov_b32 s73, 0xd0c000
    s_mov_b32 s75, 100000
    s_branch L_pw0_chk
L_pw0_retry:
    buffer_load_dword v251, v5, s[8:11], s73 offen sc1
    s_waitcnt vmcnt(0)
L_pw0_chk:
    v_cmp_ne_u32 vcc, s71, v251
    s_nop 4
    s_cbranch_vccz L_pw0_ok
    s_mov_b64 exec, vcc
    s_sleep 4
    s_sub_u32 s75, s75, 1
    s_cmp_lg_u32 s75, 0
    s_cbranch_scc1 L_pw0_retry
    s_endpgm
L_pw0_ok:
    s_mov_b64 exec, -1
    s_mov_b32 s73, 0xd0e000
    s_mov_b32 s75, 100000
    s_branch L_pw1_chk
L_pw1_retry:
    buffer_load_dword v252, v5, s[8:11], s73 offen sc1
    s_waitcnt vmcnt(0)
L_pw1_chk:
    v_cmp_ne_u32 vcc, s71, v252
    s_nop 4
    s_cbranch_vccz L_pw1_ok
    s_mov_b64 exec, vcc
    s_sleep 4
    s_sub_u32 s75, s75, 1
    s_cmp_lg_u32 s75, 0
    s_cbranch_scc1 L_pw1_retry
    s_endpgm
L_pw1_ok:
    s_mov_b64 exec, -1
    s_mov_b32 s73, 0xd10000
    s_mov_b32 s75, 100000
    s_branch L_pw2_chk
L_pw2_retry:
    buffer_load_dword v253, v5, s[8:11], s73 offen sc1
    s_waitcnt vmcnt(0)
L_pw2_chk:
    v_cmp_ne_u32 vcc, s71, v253
    s_nop 4
    s_cbranch_vccz L_pw2_ok
    s_mov_b64 exec, vcc
    s_sleep 4
    s_sub_u32 s75, s75, 1
    s_cmp_lg_u32 s75, 0
    s_cbranch_scc1 L_pw2_retry
    s_endpgm
L_pw2_ok:
    s_mov_b64 exec, -1
    s_mov_b32 s73, 0xd12000
    s_mov_b32 s75, 100000
    s_branch L_pw3_chk
L_pw3_retry:
    buffer_load_dword v254, v5, s[8:11], s73 offen sc1
    s_waitcnt vmcnt(0)
L_pw3_chk:
    v_cmp_ne_u32 vcc, s71, v254
    s_nop 4
    s_cbranch_vccz L_pw3_ok
    s_mov_b64 exec, vcc
    s_sleep 4
    s_sub_u32 s75, s75, 1
    s_cmp_lg_u32 s75, 0
    s_cbranch_scc1 L_pw3_retry
    s_endpgm
L_pw3_ok:
    s_mov_b64 exec, -1
    s_lshl_b32 s74, s2, 7
    s_add_u32 s74, s74, 0xd1d000
    v_mov_b32 v7, s71
    v_lshlrev_b32 v8, 2, v1
    s_mov_b32 exec_hi, 0
    buffer_store_dword v7, v8, s[8:11], s74 offen sc1
    s_mov_b64 exec, -1
    s_branch L_fin
L_t_recv:
    v_mov_b32 v206, 0
L_gr0:
    s_nop 0
    v_readfirstlane_b32 s72, v206
    s_nop 0
    s_cmp_eq_u32 s72, 0
    s_cbranch_scc1 L_gsr0
    ds_read_b128 v[28:31], v5 offset:20480
    ds_read_b128 v[32:35], v5 offset:21504
    s_waitcnt lgkmcnt(0)
    v_add_f32 v12, v12, v28
    v_add_f32 v13, v13, v29
    v_add_f32 v14, v14, v30
    v_add_f32 v15, v15, v31
    v_add_f32 v16, v16, v32
    v_add_f32 v17, v17, v33
    v_add_f32 v18, v18, v34
    v_add_f32 v19, v19, v35
L_t_out:
    s_nop 10
    v_fmac_f32 v216, v12, v11
    v_fmac_f32 v217, v13, v11
    v_fmac_f32 v218, v14, v11
    v_fmac_f32 v219, v15, v11
    v_fmac_f32 v220, v16, v11
    v_fmac_f32 v221, v17, v11
    v_fmac_f32 v222, v18, v11
    v_fmac_f32 v223, v19, v11
    v_fmac_f32 v224, v20, v11
    v_fmac_f32 v225, v21, v11
    v_fmac_f32 v226, v22, v11
    v_fmac_f32 v227, v23, v11
    v_fmac_f32 v228, v24, v11
    v_fmac_f32 v229, v25, v11
    v_fmac_f32 v230, v26, v11
    v_fmac_f32 v231, v27, v11
    v_cvt_pk_bf16_f32 v232, v216, v217
    v_cvt_pk_bf16_f32 v233, v218, v219
    v_cvt_pk_bf16_f32 v234, v220, v221
    v_cvt_pk_bf16_f32 v235, v222, v223
    v_cvt_pk_bf16_f32 v236, v224, v225
    v_cvt_pk_bf16_f32 v237, v226, v227
    v_cvt_pk_bf16_f32 v238, v228, v229
    v_cvt_pk_bf16_f32 v239, v230, v231
    v_permlane32_swap_b32 v232, v234
    v_permlane32_swap_b32 v233, v235
    v_permlane32_swap_b32 v236, v238
    v_permlane32_swap_b32 v237, v239
    buffer_store_dwordx4 v[232:235], v214, s[24:27], s77 offen
    s_cmp_eq_u32 s85, 2
    s_cbranch_scc1 L_fin
    buffer_store_dwordx4 v[236:239], v214, s[24:27], s77 offen offset:32
L_fin:
    s_endpgm
L_sfr0:
    ds_read_b128 v[24:27], v20 offset:16
    s_sub_u32 s75, s75, 1
    s_cmp_eq_u32 s75, 0
    s_cbranch_scc1 L_end
    s_branch L_sf0
L_sfr1:
    ds_read_b128 v[24:27], v20 offset:16
    s_sub_u32 s75, s75, 1
    s_cmp_eq_u32 s75, 0
    s_cbranch_scc1 L_end
    s_branch L_sf1
L_sfr2:
    ds_read_b128 v[24:27], v20 offset:16
    s_sub_u32 s75, s75, 1
    s_cmp_eq_u32 s75, 0
    s_cbranch_scc1 L_end
    s_branch L_sf2
L_sfr3:
    ds_read_b128 v[24:27], v20 offset:16
    s_sub_u32 s75, s75, 1
    s_cmp_eq_u32 s75, 0
    s_cbranch_scc1 L_end
    s_branch L_sf3
L_sfr4:
    ds_read_b128 v[24:27], v20 offset:16
    s_sub_u32 s75, s75, 1
    s_cmp_eq_u32 s75, 0
    s_cbranch_scc1 L_end
    s_branch L_sf4
L_sfr5:
    ds_read_b128 v[24:27], v20 offset:16
    s_sub_u32 s75, s75, 1
    s_cmp_eq_u32 s75, 0
    s_cbranch_scc1 L_end
    s_branch L_sf5
L_gp0:
    s_sleep 1
    ds_read_b32 v114, v112
    s_sub_u32 s75, s75, 1
    s_cmp_eq_u32 s75, 0
    s_cbranch_scc1 L_end
    s_waitcnt lgkmcnt(0)
    s_branch L_gc0
L_gp1:
    s_sleep 1
    ds_read_b32 v114, v112
    s_sub_u32 s75, s75, 1
    s_cmp_eq_u32 s75, 0
    s_cbranch_scc1 L_end
    s_waitcnt lgkmcnt(0)
    s_branch L_gc1
L_gp2:
    s_sleep 1
    ds_read_b32 v114, v112
    s_sub_u32 s75, s75, 1
    s_cmp_eq_u32 s75, 0
    s_cbranch_scc1 L_end
    s_waitcnt lgkmcnt(0)
    s_branch L_gc2
L_gp3:
    s_sleep 1
    ds_read_b32 v114, v112
    s_sub_u32 s75, s75, 1
    s_cmp_eq_u32 s75, 0
    s_cbranch_scc1 L_end
    s_waitcnt lgkmcnt(0)
    s_branch L_gc3
L_gp4:
    s_sleep 1
    ds_read_b32 v114, v112
    s_sub_u32 s75, s75, 1
    s_cmp_eq_u32 s75, 0
    s_cbranch_scc1 L_end
    s_waitcnt lgkmcnt(0)
    s_branch L_gc4
L_gp5:
    s_sleep 1
    ds_read_b32 v114, v112
    s_sub_u32 s75, s75, 1
    s_cmp_eq_u32 s75, 0
    s_cbranch_scc1 L_end
    s_waitcnt lgkmcnt(0)
    s_branch L_gc5
L_gp6:
    s_sleep 1
    ds_read_b32 v114, v112
    s_sub_u32 s75, s75, 1
    s_cmp_eq_u32 s75, 0
    s_cbranch_scc1 L_end
    s_waitcnt lgkmcnt(0)
    s_branch L_gc6
L_gp7:
    s_sleep 1
    ds_read_b32 v114, v112
    s_sub_u32 s75, s75, 1
    s_cmp_eq_u32 s75, 0
    s_cbranch_scc1 L_end
    s_waitcnt lgkmcnt(0)
    s_branch L_gc7
L_gp8:
    s_sleep 1
    ds_read_b32 v114, v112
    s_sub_u32 s75, s75, 1
    s_cmp_eq_u32 s75, 0
    s_cbranch_scc1 L_end
    s_waitcnt lgkmcnt(0)
    s_branch L_gc8
L_gp9:
    s_sleep 1
    ds_read_b32 v114, v112
    s_sub_u32 s75, s75, 1
    s_cmp_eq_u32 s75, 0
    s_cbranch_scc1 L_end
    s_waitcnt lgkmcnt(0)
    s_branch L_gc9
L_cpf:
    s_mov_b64 exec, s[94:95]
    buffer_load_dwordx2 v[208:209], v214, s[8:11], 0 offen sc1
    s_mov_b64 exec, -1
    s_branch L_cpf_e
L_ckf:
    buffer_load_dwordx4 v[128:131], v80, s[8:11], s79 offen offset:2048 sc1
    buffer_load_dwordx4 v[136:139], v81, s[8:11], s79 offen offset:2048 sc1
    s_mul_i32 s78, s80, 5120
    s_add_u32 s80, s80, 1
    s_add_u32 s78, s78, s79
    s_and_b32 s80, s80, 3
    buffer_load_dwordx4 v[96:99], v4, s[8:11], s78 offen offset:0 sc1
    s_mov_b64 exec, s[90:91]
    buffer_load_dwordx4 v[144:147], v249, s[8:11], s78 offen offset:2560 sc1
    buffer_load_dwordx4 v[148:151], v250, s[8:11], s78 offen offset:2560 sc1
    s_mov_b64 exec, -1
    buffer_load_dwordx4 v[100:103], v4, s[8:11], s78 offen offset:1024 sc1
    s_mov_b64 exec, s[90:91]
    buffer_load_dwordx4 v[152:155], v249, s[8:11], s78 offen offset:3840 sc1
    buffer_load_dwordx4 v[156:159], v250, s[8:11], s78 offen offset:3840 sc1
    s_mov_b64 exec, -1
    s_mul_i32 s78, s80, 5120
    s_add_u32 s80, s80, 1
    s_add_u32 s78, s78, s79
    s_and_b32 s80, s80, 3
    buffer_load_dwordx4 v[104:107], v4, s[8:11], s78 offen offset:0 sc1
    s_mov_b64 exec, s[90:91]
    buffer_load_dwordx4 v[160:163], v249, s[8:11], s78 offen offset:2560 sc1
    buffer_load_dwordx4 v[164:167], v250, s[8:11], s78 offen offset:2560 sc1
    s_mov_b64 exec, -1
    s_branch L_ckf_e
L_cpt:
    s_mov_b64 exec, s[94:95]
    buffer_load_dwordx2 v[208:209], v214, s[8:11], 0 offen sc1
    s_mov_b64 exec, -1
    s_branch L_cpt_e
L_ckt:
    buffer_load_dwordx4 v[128:131], v80, s[8:11], s79 offen offset:2048 sc1
    buffer_load_dwordx4 v[136:139], v81, s[8:11], s79 offen offset:2048 sc1
    s_mul_i32 s78, s80, 5120
    s_add_u32 s80, s80, 1
    s_add_u32 s78, s78, s79
    s_and_b32 s80, s80, 3
    buffer_load_dwordx4 v[96:99], v4, s[8:11], s78 offen offset:0 sc1
    s_mov_b64 exec, s[90:91]
    buffer_load_dwordx4 v[144:147], v249, s[8:11], s78 offen offset:2560 sc1
    buffer_load_dwordx4 v[148:151], v250, s[8:11], s78 offen offset:2560 sc1
    s_mov_b64 exec, -1
    buffer_load_dwordx4 v[100:103], v4, s[8:11], s78 offen offset:1024 sc1
    s_mov_b64 exec, s[90:91]
    buffer_load_dwordx4 v[152:155], v249, s[8:11], s78 offen offset:3840 sc1
    buffer_load_dwordx4 v[156:159], v250, s[8:11], s78 offen offset:3840 sc1
    s_mov_b64 exec, -1
    s_mul_i32 s78, s80, 5120
    s_add_u32 s80, s80, 1
    s_add_u32 s78, s78, s79
    s_and_b32 s80, s80, 3
    buffer_load_dwordx4 v[104:107], v4, s[8:11], s78 offen offset:0 sc1
    s_mov_b64 exec, s[90:91]
    buffer_load_dwordx4 v[160:163], v249, s[8:11], s78 offen offset:2560 sc1
    buffer_load_dwordx4 v[164:167], v250, s[8:11], s78 offen offset:2560 sc1
    s_mov_b64 exec, -1
    s_branch L_ckt_e
L_fy:
    s_lshl_b32 s74, s2, 7
    s_add_u32 s74, s74, 0xd0c000
    v_mov_b32 v7, s71
    v_lshlrev_b32 v8, 2, v1
    s_mov_b32 exec_hi, 0
    buffer_store_dword v7, v8, s[8:11], s74 offen sc1
    s_mov_b64 exec, -1
    s_branch L_nofy
L_py_retry0:
    s_mov_b32 s75, 100000
L_py_retry:
    buffer_load_dword v76, v9, s[8:11], 0 offen sc1
    s_waitcnt vmcnt(0)
L_py_chk:
    v_cmp_ne_u32 vcc, s71, v76
    s_nop 4
    s_cbranch_vccz L_py_ok
    s_mov_b64 exec, vcc
    s_sleep 8
    s_sub_u32 s75, s75, 1
    s_cmp_lg_u32 s75, 0
    s_cbranch_scc1 L_py_retry
    s_endpgm
L_py_ok:
    s_mov_b64 exec, -1
    s_branch L_py_back
L_y2:
    s_add_u32 m0, s72, 12288
    s_add_u32 s81, s81, 67584
    buffer_load_dwordx4 v5, s[8:11], s81 offen sc1 lds
    s_lshl_b32 s74, s2, 3
    s_add_u32 s74, s74, s68
    s_cmp_lg_u32 s74, 7
    s_cbranch_scc1 L_y2_e
    v_lshlrev_b32 v5, 7, v1
    s_mov_b32 s74, 0xd0c000
    buffer_load_dword v251, v5, s[8:11], s74 offen sc1
    s_mov_b32 s74, 0xd0e000
    buffer_load_dword v252, v5, s[8:11], s74 offen sc1
    s_mov_b32 s74, 0xd10000
    buffer_load_dword v253, v5, s[8:11], s74 offen sc1
    s_mov_b32 s74, 0xd12000
    buffer_load_dword v254, v5, s[8:11], s74 offen sc1
    s_branch L_y2_e
L_gsb1:
    ds_read_b32 v207, v249 offset:4
    s_sub_u32 s75, s75, 1
    s_cmp_eq_u32 s75, 0
    s_cbranch_scc1 L_end
    s_waitcnt lgkmcnt(0)
    s_branch L_gb1
L_gsb2:
    ds_read_b32 v206, v249 offset:8
    s_sub_u32 s75, s75, 1
    s_cmp_eq_u32 s75, 0
    s_cbranch_scc1 L_end
    s_waitcnt lgkmcnt(0)
    s_branch L_gb2
L_gsb3:
    ds_read_b32 v207, v249 offset:12
    s_sub_u32 s75, s75, 1
    s_cmp_eq_u32 s75, 0
    s_cbranch_scc1 L_end
    s_waitcnt lgkmcnt(0)
    s_branch L_gb3
L_gsb4:
    ds_read_b32 v206, v249 offset:16
    s_sub_u32 s75, s75, 1
    s_cmp_eq_u32 s75, 0
    s_cbranch_scc1 L_end
    s_waitcnt lgkmcnt(0)
    s_branch L_gb4
L_gsb5:
    ds_read_b32 v207, v249 offset:20
    s_sub_u32 s75, s75, 1
    s_cmp_eq_u32 s75, 0
    s_cbranch_scc1 L_end
    s_waitcnt lgkmcnt(0)
    s_branch L_gb5
L_gsb6:
    ds_read_b32 v206, v249 offset:24
    s_sub_u32 s75, s75, 1
    s_cmp_eq_u32 s75, 0
    s_cbranch_scc1 L_end
    s_waitcnt lgkmcnt(0)
    s_branch L_gb6
L_gsb7:
    ds_read_b32 v207, v249 offset:28
    s_sub_u32 s75, s75, 1
    s_cmp_eq_u32 s75, 0
    s_cbranch_scc1 L_end
    s_waitcnt lgkmcnt(0)
    s_branch L_gb7
L_gsz0:
    ds_read_b32 v206, v249 offset:0
    s_sub_u32 s75, s75, 1
    s_cmp_eq_u32 s75, 0
    s_cbranch_scc1 L_end
    s_waitcnt lgkmcnt(0)
    s_branch L_gz0
L_gss1:
    ds_read_b32 v207, v249 offset:8
    s_sub_u32 s75, s75, 1
    s_cmp_eq_u32 s75, 0
    s_cbranch_scc1 L_end
    s_waitcnt lgkmcnt(0)
    s_branch L_gs1
L_gss2:
    ds_read_b32 v206, v249 offset:16
    s_sub_u32 s75, s75, 1
    s_cmp_eq_u32 s75, 0
    s_cbranch_scc1 L_end
    s_waitcnt lgkmcnt(0)
    s_branch L_gs2
L_gss3:
    ds_read_b32 v207, v249 offset:24
    s_sub_u32 s75, s75, 1
    s_cmp_eq_u32 s75, 0
    s_cbranch_scc1 L_end
    s_waitcnt lgkmcnt(0)
    s_branch L_gs3
L_gsr0:
    ds_read_b32 v206, v249 offset:0
    s_sub_u32 s75, s75, 1
    s_cmp_eq_u32 s75, 0
    s_cbranch_scc1 L_end
    s_waitcnt lgkmcnt(0)
    s_branch L_gr0
L_end:
    s_endpgm
.section .rodata,"a"
.p2align 6
.amdhsa_kernel gated_mix__ssm_conv_s4d__grouped_kv_mqa__prompt_kernel
  .amdhsa_next_free_vgpr 255
  .amdhsa_next_free_sgpr 96
  .amdhsa_accum_offset 256
  .amdhsa_group_segment_fixed_size 0
  .amdhsa_kernarg_size 128
  .amdhsa_user_sgpr_count 2
  .amdhsa_user_sgpr_kernarg_segment_ptr 1
  .amdhsa_system_sgpr_workgroup_id_x 1
.end_amdhsa_kernel
```
